```python
import torch

def _softmax(x, axis=-1):
    return torch.softmax(x, dim=axis)
def _gelu(x):
    return torch.nn.functional.gelu(x, approximate="tanh")
def _silu(x):
    return torch.nn.functional.silu(x)
def _sigmoid(x):
    return torch.sigmoid(x)
def _layernorm(x, axis=-1, eps=1e-5):
    m = x.mean(dim=axis, keepdim=True)
    v = x.var(dim=axis, keepdim=True, unbiased=False)
    return (x - m) / torch.sqrt(v + eps)
def _scatter_add(tgt, idx, src, axis=0):
    return tgt.clone().index_add_(axis, idx, src)
def _segment_sum(src, seg, n):
    out = torch.zeros((n,) + src.shape[1:], dtype=src.dtype)
    return out.index_add_(0, seg, src)
def _pad(x, pw):
    flat = tuple(v for pair in reversed(pw) for v in pair)
    return torch.nn.functional.pad(x, flat)

kernel_name = 'recurrent_scan__mha_block_cached__swiglu_ffn__decode'

def setup_inputs():

    _w = (lambda a: (lambda t: t.to(torch.bfloat16) if t.is_floating_point() else t)(torch.as_tensor(a)))
    def _A_setup():
        B, Sq, D = 2, 1, 1024
        H, Sk, Dh = 32, 16384, 128
        return {
            "x": _w((lambda *s: torch.randn(*s, dtype=torch.bfloat16) * 0.05)(B, Sq, D)),
            "k_cache": _w((lambda *s: torch.randn(*s, dtype=torch.bfloat16) * 1.6)(B, H, Sk, Dh)),
            "v_cache": _w((lambda *s: torch.randn(*s, dtype=torch.bfloat16) * 0.2)(B, H, Sk, Dh)),
            "wq": _w((lambda *s: torch.randn(*s, dtype=torch.bfloat16) * 1.6)(D, H * Dh) * (D ** -0.5)),
            "wo": _w((lambda *s: torch.randn(*s, dtype=torch.bfloat16) * 0.2)(H * Dh, D) * ((H * Dh) ** -0.5)),
        }
    _A_in = _A_setup()

    def _B_setup():
        B, S, D, F = 2, 1, 1024, 3584
        return {
            "x": _w((lambda *s: torch.randn(*s, dtype=torch.bfloat16) * 0.05)(B, S, D)),
            "w_gate": _w((lambda *s: torch.randn(*s, dtype=torch.bfloat16) * 0.1)(D, F)),
            "w_up": _w((lambda *s: torch.randn(*s, dtype=torch.bfloat16) * 0.1)(D, F)),
            "w_down": _w((lambda *s: torch.randn(*s, dtype=torch.bfloat16) * 0.1)(F, D)),
        }
    _B_in = _B_setup()

    return {
        "A_x": _A_in["x"],
        "A_k_cache": _A_in["k_cache"],
        "A_v_cache": _A_in["v_cache"],
        "A_wq": _A_in["wq"],
        "A_wo": _A_in["wo"],
        "B_x": _B_in["x"],
        "B_w_gate": _B_in["w_gate"],
        "B_w_up": _B_in["w_up"],
        "B_w_down": _B_in["w_down"],
    }

def reference(A_x, A_k_cache, A_v_cache, A_wq, A_wo, B_x, B_w_gate, B_w_up, B_w_down):
    def _A_ref(x, k_cache, v_cache, wq, wo):
        B, Sq, D = x.shape
        H, Dh = 32, 128
        q = (lambda x, *d: x.permute(*d))((x @ wq).reshape(B, Sq, H, Dh), 0, 2, 1, 3)
        scores = torch.einsum("bhqd,bhkd->bhqk", q, k_cache) * (Dh ** -0.5)
        p = _softmax(scores, axis=-1)
        o = torch.einsum("bhqk,bhkd->bhqd", p, v_cache)
        return (lambda x, *d: x.permute(*d))(o, 0, 2, 1, 3).reshape(B, Sq, H * Dh) @ wo

    def _B_ref(x, w_gate, w_up, w_down):
        g = _silu(x @ w_gate)
        u = x @ w_up
        return (g * u) @ w_down

    x = A_x
    xn = _layernorm(x, axis=-1)
    s = _A_ref(xn, A_k_cache, A_v_cache, A_wq, A_wo)
    g = _silu(_B_ref(xn, B_w_gate, B_w_up, B_w_down))
    return x + s * g
```

```asm
; @launch grid=(256,1,1) block=(512,1,1) lds=28672
.amdgcn_target "amdgcn-amd-amdhsa--gfx950"
.text
.globl recurrent_scan__mha_block_cached__swiglu_ffn__decode_kernel
.p2align 8
.type recurrent_scan__mha_block_cached__swiglu_ffn__decode_kernel,@function
recurrent_scan__mha_block_cached__swiglu_ffn__decode_kernel:
    s_cmp_ge_u32 s2, 256
    s_cbranch_scc1 L_END
    s_load_dwordx16 s[68:83], s[0:1], 0
    s_load_dwordx8 s[84:91], s[0:1], 64
    v_lshrrev_b32 v14, 6, v0
    v_and_b32 v1, 63, v0
    v_readfirstlane_b32 s3, v14
    s_lshr_b32 s4, s2, 3
    s_and_b32 s5, s2, 7
    s_bcnt1_i32_b32 s6, s5
    s_and_b32 s6, s6, 1
    s_lshr_b32 s7, s5, 1
    s_sub_u32 s4, s4, s7
    s_and_b32 s4, s4, 31
    v_and_b32 v15, 15, v1
    v_lshrrev_b32 v16, 4, v1
    v_lshlrev_b32 v2, 4, v1
    s_lshl_b32 s57, s3, 4
    v_add_u32 v17, s57, v16
    v_lshlrev_b32 v18, 4, v15
    v_lshlrev_b32 v3, 13, v17
    v_add_u32 v3, v3, v18
    v_mul_u32_u24 v4, 7168, v17
    v_add_u32 v4, v4, v18
    v_lshlrev_b32 v5, 11, v17
    v_add_u32 v5, v5, v18
    v_lshlrev_b32 v19, 4, v1
    v_and_b32 v21, 31, v1
    v_lshlrev_b32 v20, 3, v21
    v_lshrrev_b32 v22, 5, v1
    v_lshlrev_b32 v23, 11, v22
    v_add_u32 v20, v20, v23
    s_mov_b32 s10, 0x1000
    s_mov_b32 s11, 0x20000
    s_mov_b32 s14, 0x10000000
    s_mov_b32 s15, 0x20000
    s_mov_b32 s18, 0x10000000
    s_mov_b32 s19, 0x20000
    s_mov_b32 s22, 0x800000
    s_mov_b32 s23, 0x20000
    s_mov_b32 s34, 0x800000
    s_mov_b32 s35, 0x20000
    s_mov_b32 s42, 0x1000
    s_mov_b32 s43, 0x20000
    s_mov_b32 s46, 0x428000
    s_mov_b32 s47, 0x20000
    s_mov_b32 s50, 0x100
    s_mov_b32 s51, 0x20000
    s_cmp_lt_u32 s4, 28
    s_cselect_b32 s26, 0x700000, 0
    s_mov_b32 s27, 0x20000
    s_cselect_b32 s30, 0x700000, 0
    s_mov_b32 s31, 0x20000
    s_cselect_b32 s38, 0x700000, 0
    s_mov_b32 s39, 0x20000
    s_lshl_b32 s64, s4, 3
    s_add_u32 s64, s64, s5
    s_mul_i32 s64, s64, 16896
    s_add_u32 s64, s64, 32768
    s_mul_i32 s65, s4, 135168
    s_add_u32 s65, s65, 32768
    s_lshl_b32 s57, s4, 8
    s_lshl_b32 s100, s5, 20
    s_add_u32 s100, s100, s57
    s_mul_i32 s101, s5, 917504
    s_add_u32 s101, s101, s57
    s_lshl_b32 s67, s4, 18
    s_lshl_b32 s57, s5, 8
    s_add_u32 s67, s67, s57
    s_lshl_b32 s60, s5, 8
    s_waitcnt lgkmcnt(0)
    s_mov_b64 s[8:9], s[68:69]
    s_mov_b64 s[12:13], s[70:71]
    s_mov_b64 s[16:17], s[72:73]
    s_mov_b64 s[20:21], s[74:75]
    s_mov_b64 s[32:33], s[76:77]
    s_mov_b64 s[24:25], s[80:81]
    s_mov_b64 s[28:29], s[82:83]
    s_mov_b64 s[36:37], s[84:85]
    s_mov_b64 s[40:41], s[86:87]
    s_mov_b64 s[48:49], s[88:89]
    s_mov_b64 s[44:45], s[90:91]
    s_lshl_b32 s57, s6, 5
    s_add_u32 s57, s57, s4
    s_lshl_b32 s76, s57, 22
    s_lshl_b32 s57, s7, 20
    s_add_u32 s84, s76, s57
    s_lshl_b32 s57, s3, 12
    s_add_u32 s84, s84, s57
    s_mov_b32 s83, s84
    s_lshl_b32 s57, s4, 1
    s_add_u32 s57, s57, s6
    s_lshl_b32 s57, s57, 8
    s_add_u32 s77, s57, 4096
    s_add_u32 s85, s77, 128
    buffer_load_dwordx2 v[244:245], off, s[44:47], 0
    s_cmp_lg_u32 s3, 0
    s_cbranch_scc1 L_w0a_1
    s_setprio 3
    s_cmp_lg_u32 s5, 0
    s_cbranch_scc1 L_nz_2
    v_lshlrev_b32 v232, 7, v1
    v_mov_b32 v233, 0
    s_lshl_b32 s57, s4, 9
    s_add_u32 s57, s57, 4096
    s_mov_b64 exec, 15
    buffer_store_dword v233, v232, s[44:47], s57 offen sc0 sc1
    s_mov_b64 exec, -1
L_nz_2:
    buffer_load_dwordx4 v[212:215], v19, s[8:11], 0 offen offset:0
    buffer_load_dwordx4 v[216:219], v19, s[8:11], 0 offen offset:1024
    buffer_load_dwordx4 v[220:223], v19, s[8:11], 0 offen offset:2048
    buffer_load_dwordx4 v[224:227], v19, s[8:11], 0 offen offset:3072
    buffer_load_dwordx2 v[228:229], v20, s[8:11], s60 offen
    buffer_load_dwordx4 v[68:71], v3, s[20:23], s100 offen nt
    s_add_u32 s100, s100, 32768
    buffer_load_dwordx4 v[72:75], v3, s[20:23], s100 offen nt
    s_add_u32 s100, s100, 32768
    buffer_load_dwordx4 v[76:79], v3, s[20:23], s100 offen nt
    s_add_u32 s100, s100, 32768
    buffer_load_dwordx4 v[80:83], v3, s[20:23], s100 offen nt
    s_add_u32 s100, s100, 32768
    buffer_load_dwordx4 v[84:87], v3, s[20:23], s100 offen nt
    s_add_u32 s100, s100, 32768
    buffer_load_dwordx4 v[88:91], v3, s[20:23], s100 offen nt
    s_add_u32 s100, s100, 32768
    buffer_load_dwordx4 v[92:95], v3, s[20:23], s100 offen nt
    s_add_u32 s100, s100, 32768
    buffer_load_dwordx4 v[96:99], v3, s[20:23], s100 offen nt
    s_add_u32 s100, s100, 32768
    buffer_load_dwordx4 v[100:103], v3, s[20:23], s100 offen nt
    s_add_u32 s100, s100, 32768
    buffer_load_dwordx4 v[104:107], v3, s[20:23], s100 offen nt
    s_add_u32 s100, s100, 32768
    buffer_load_dwordx4 v[108:111], v3, s[20:23], s100 offen nt
    s_add_u32 s100, s100, 32768
    buffer_load_dwordx4 v[112:115], v3, s[20:23], s100 offen nt
    s_add_u32 s100, s100, 32768
    buffer_load_dwordx4 v[116:119], v3, s[20:23], s100 offen nt
    s_add_u32 s100, s100, 32768
    buffer_load_dwordx4 v[120:123], v3, s[20:23], s100 offen nt
    s_add_u32 s100, s100, 32768
    buffer_load_dwordx4 v[124:127], v3, s[20:23], s100 offen nt
    s_add_u32 s100, s100, 32768
    buffer_load_dwordx4 v[128:131], v3, s[20:23], s100 offen nt
    s_add_u32 s100, s100, 32768
    buffer_load_dwordx4 v[132:135], v3, s[20:23], s100 offen nt
    s_add_u32 s100, s100, 32768
    buffer_load_dwordx4 v[136:139], v3, s[20:23], s100 offen nt
    s_add_u32 s100, s100, 32768
    buffer_load_dwordx4 v[140:143], v3, s[20:23], s100 offen nt
    s_add_u32 s100, s100, 32768
    buffer_load_dwordx4 v[144:147], v3, s[20:23], s100 offen nt
    s_add_u32 s100, s100, 32768
    buffer_load_dwordx4 v[148:151], v3, s[20:23], s100 offen nt
    s_add_u32 s100, s100, 32768
    buffer_load_dwordx4 v[152:155], v3, s[20:23], s100 offen nt
    s_add_u32 s100, s100, 32768
    buffer_load_dwordx4 v[156:159], v3, s[20:23], s100 offen nt
    s_add_u32 s100, s100, 32768
    buffer_load_dwordx4 v[160:163], v3, s[20:23], s100 offen nt
    s_add_u32 s100, s100, 32768
    buffer_load_dwordx4 v[164:167], v3, s[20:23], s100 offen nt
    s_add_u32 s100, s100, 32768
    buffer_load_dwordx4 v[168:171], v3, s[20:23], s100 offen nt
    s_add_u32 s100, s100, 32768
    buffer_load_dwordx4 v[172:175], v3, s[20:23], s100 offen nt
    s_add_u32 s100, s100, 32768
    buffer_load_dwordx4 v[176:179], v3, s[20:23], s100 offen nt
    s_add_u32 s100, s100, 32768
    buffer_load_dwordx4 v[180:183], v3, s[20:23], s100 offen nt
    s_add_u32 s100, s100, 32768
    buffer_load_dwordx4 v[184:187], v3, s[20:23], s100 offen nt
    s_add_u32 s100, s100, 32768
    buffer_load_dwordx4 v[188:191], v3, s[20:23], s100 offen nt
    s_add_u32 s100, s100, 32768
    buffer_load_dwordx4 v[192:195], v3, s[20:23], s100 offen nt
L_w0a_1:
    s_barrier
    s_cmp_eq_u32 s3, 0
    s_cbranch_scc1 L_w0b_3
    buffer_load_dwordx4 v[148:151], v4, s[24:27], s101 offen nt
    s_add_u32 s63, s101, 28672
    buffer_load_dwordx4 v[152:155], v4, s[24:27], s63 offen nt
    s_add_u32 s63, s101, 57344
    buffer_load_dwordx4 v[156:159], v4, s[24:27], s63 offen nt
    s_waitcnt vmcnt(2)
    s_add_u32 s63, s101, 86016
    buffer_load_dwordx4 v[160:163], v4, s[24:27], s63 offen nt
    s_waitcnt vmcnt(2)
    buffer_load_dwordx4 v[164:167], v4, s[28:31], s101 offen nt
    s_waitcnt vmcnt(2)
    s_add_u32 s63, s101, 28672
    buffer_load_dwordx4 v[168:171], v4, s[28:31], s63 offen nt
    s_waitcnt vmcnt(2)
    s_add_u32 s63, s101, 57344
    buffer_load_dwordx4 v[172:175], v4, s[28:31], s63 offen nt
    s_waitcnt vmcnt(2)
    s_add_u32 s63, s101, 86016
    buffer_load_dwordx4 v[176:179], v4, s[28:31], s63 offen nt
    s_waitcnt vmcnt(2)
    s_mov_b32 s54, s84
    buffer_load_dwordx4 v[68:71], v2, s[12:15], s54 offen offset:0 nt
    s_waitcnt vmcnt(2)
    buffer_load_dwordx4 v[72:75], v2, s[12:15], s54 offen offset:1024 nt
    s_waitcnt vmcnt(2)
    buffer_load_dwordx4 v[76:79], v2, s[12:15], s54 offen offset:2048 nt
    s_waitcnt vmcnt(2)
    buffer_load_dwordx4 v[80:83], v2, s[12:15], s54 offen offset:3072 nt
    s_waitcnt vmcnt(2)
    s_add_u32 s54, s54, 32768
    buffer_load_dwordx4 v[84:87], v2, s[12:15], s54 offen offset:0 nt
    s_waitcnt vmcnt(2)
    buffer_load_dwordx4 v[88:91], v2, s[12:15], s54 offen offset:1024 nt
    s_waitcnt vmcnt(2)
    buffer_load_dwordx4 v[92:95], v2, s[12:15], s54 offen offset:2048 nt
    s_waitcnt vmcnt(2)
    buffer_load_dwordx4 v[96:99], v2, s[12:15], s54 offen offset:3072 nt
L_w0b_3:
    v_and_b32 v25, 1, v1
    v_lshlrev_b32 v25, 4, v25
    v_mov_b32 v26, 0xffff
    v_lshlrev_b32 v25, v25, v26
    v_bfe_u32 v26, v1, 1, 2
    v_cmp_eq_u32 vcc, 0, v26
    s_nop 1
    v_cndmask_b32 v32, 0, v25, vcc
    v_cmp_eq_u32 vcc, 1, v26
    s_nop 1
    v_cndmask_b32 v33, 0, v25, vcc
    v_cmp_eq_u32 vcc, 2, v26
    s_nop 1
    v_cndmask_b32 v34, 0, v25, vcc
    v_cmp_eq_u32 vcc, 3, v26
    s_nop 1
    v_cndmask_b32 v35, 0, v25, vcc
    s_mov_b32 s94, 0xaaaaaaaa
    s_mov_b32 s95, 0xaaaaaaaa
    s_mov_b32 s96, 0xcccccccc
    s_mov_b32 s97, 0xcccccccc
    v_bfe_u32 v25, v1, 3, 1
    v_lshlrev_b32 v25, 5, v25
    v_add_u32 v25, v25, v16
    s_lshl_b32 s57, s3, 2
    v_add_u32 v25, s57, v25
    v_lshlrev_b32 v6, 4, v25
    s_lshl_b32 s57, s3, 10
    v_lshlrev_b32 v7, 4, v1
    v_add_u32 v7, s57, v7
    v_lshlrev_b32 v25, 4, v16
    v_and_b32 v26, 3, v1
    v_lshlrev_b32 v26, 1, v26
    v_add_u32 v25, v25, v26
    s_and_b32 s57, s3, 1
    s_lshl_b32 s57, s57, 3
    v_add_u32 v25, s57, v25
    v_lshlrev_b32 v25, 4, v25
    v_bfe_u32 v26, v1, 2, 2
    v_lshlrev_b32 v26, 2, v26
    v_add_u32 v8, v25, v26
    v_lshrrev_b32 v25, 3, v1
    v_lshlrev_b32 v25, 2, v25
    v_and_b32 v26, 1, v1
    v_lshlrev_b32 v26, 1, v26
    v_add_u32 v25, v25, v26
    v_lshlrev_b32 v25, 2, v25
    v_bfe_u32 v26, v1, 1, 2
    v_add_u32 v25, v25, v26
    v_lshlrev_b32 v9, 2, v25
    v_mov_b32 v232, 0x7ff00000
    v_mov_b32 v233, 0x7ff00000
    v_mov_b32 v11, 0xff7fffff
    v_mov_b32 v12, 0
    v_mov_b32 v40, 0
    v_mov_b32 v41, 0
    v_mov_b32 v42, 0
    v_mov_b32 v43, 0
    s_cmp_lg_u32 s3, 0
    s_cbranch_scc1 L_w0c_4
    s_waitcnt vmcnt(32)
    v_add_u32 v244, 1, v244
    v_add_u32 v245, 1, v245
    v_lshlrev_b32 v52, 16, v212
    v_and_b32 v53, 0xffff0000, v212
    v_lshlrev_b32 v54, 16, v213
    v_and_b32 v55, 0xffff0000, v213
    v_lshlrev_b32 v56, 16, v214
    v_and_b32 v57, 0xffff0000, v214
    v_lshlrev_b32 v58, 16, v215
    v_and_b32 v59, 0xffff0000, v215
    v_lshlrev_b32 v60, 16, v216
    v_and_b32 v61, 0xffff0000, v216
    v_lshlrev_b32 v62, 16, v217
    v_and_b32 v63, 0xffff0000, v217
    v_lshlrev_b32 v64, 16, v218
    v_and_b32 v65, 0xffff0000, v218
    v_lshlrev_b32 v66, 16, v219
    v_and_b32 v67, 0xffff0000, v219
    v_lshlrev_b32 v196, 16, v220
    v_and_b32 v197, 0xffff0000, v220
    v_lshlrev_b32 v198, 16, v221
    v_and_b32 v199, 0xffff0000, v221
    v_lshlrev_b32 v200, 16, v222
    v_and_b32 v201, 0xffff0000, v222
    v_lshlrev_b32 v202, 16, v223
    v_and_b32 v203, 0xffff0000, v223
    v_lshlrev_b32 v204, 16, v224
    v_and_b32 v205, 0xffff0000, v224
    v_lshlrev_b32 v206, 16, v225
    v_and_b32 v207, 0xffff0000, v225
    v_lshlrev_b32 v208, 16, v226
    v_and_b32 v209, 0xffff0000, v226
    v_lshlrev_b32 v210, 16, v227
    v_and_b32 v211, 0xffff0000, v227
    v_add_f32 v14, v52, v53
    v_add_f32 v15, v196, v197
    v_add_f32 v14, v14, v54
    v_add_f32 v15, v15, v198
    v_add_f32 v14, v14, v55
    v_add_f32 v15, v15, v199
    v_add_f32 v14, v14, v56
    v_add_f32 v15, v15, v200
    v_add_f32 v14, v14, v57
    v_add_f32 v15, v15, v201
    v_add_f32 v14, v14, v58
    v_add_f32 v15, v15, v202
    v_add_f32 v14, v14, v59
    v_add_f32 v15, v15, v203
    v_add_f32 v14, v14, v60
    v_add_f32 v15, v15, v204
    v_add_f32 v14, v14, v61
    v_add_f32 v15, v15, v205
    v_add_f32 v14, v14, v62
    v_add_f32 v15, v15, v206
    v_add_f32 v14, v14, v63
    v_add_f32 v15, v15, v207
    v_add_f32 v14, v14, v64
    v_add_f32 v15, v15, v208
    v_add_f32 v14, v14, v65
    v_add_f32 v15, v15, v209
    v_add_f32 v14, v14, v66
    v_add_f32 v15, v15, v210
    v_add_f32 v14, v14, v67
    v_add_f32 v15, v15, v211
    s_nop 1
    v_add_f32_dpp v14, v14, v14 row_ror:8 row_mask:0xf bank_mask:0xf
    v_add_f32_dpp v15, v15, v15 row_ror:8 row_mask:0xf bank_mask:0xf
    s_nop 0
    v_add_f32_dpp v14, v14, v14 row_ror:4 row_mask:0xf bank_mask:0xf
    v_add_f32_dpp v15, v15, v15 row_ror:4 row_mask:0xf bank_mask:0xf
    s_nop 0
    v_add_f32_dpp v14, v14, v14 row_ror:2 row_mask:0xf bank_mask:0xf
    v_add_f32_dpp v15, v15, v15 row_ror:2 row_mask:0xf bank_mask:0xf
    s_nop 0
    v_add_f32_dpp v14, v14, v14 row_ror:1 row_mask:0xf bank_mask:0xf
    v_add_f32_dpp v15, v15, v15 row_ror:1 row_mask:0xf bank_mask:0xf
    v_mov_b32 v16, v14
    v_mov_b32 v17, v15
    s_nop 1
    v_permlane16_swap_b32 v14, v16
    v_permlane16_swap_b32 v15, v17
    s_nop 0
    v_add_f32 v14, v14, v16
    v_add_f32 v15, v15, v17
    v_mov_b32 v16, v14
    v_mov_b32 v17, v15
    s_nop 1
    v_permlane32_swap_b32 v14, v16
    v_permlane32_swap_b32 v15, v17
    s_nop 0
    v_add_f32 v14, v14, v16
    v_add_f32 v15, v15, v17
    v_mul_f32 v24, 0x3a800000, v14
    v_mul_f32 v25, 0x3a800000, v15
    v_sub_f32 v52, v52, v24
    v_sub_f32 v196, v196, v25
    v_sub_f32 v53, v53, v24
    v_sub_f32 v197, v197, v25
    v_sub_f32 v54, v54, v24
    v_sub_f32 v198, v198, v25
    v_sub_f32 v55, v55, v24
    v_sub_f32 v199, v199, v25
    v_sub_f32 v56, v56, v24
    v_sub_f32 v200, v200, v25
    v_sub_f32 v57, v57, v24
    v_sub_f32 v201, v201, v25
    v_sub_f32 v58, v58, v24
    v_sub_f32 v202, v202, v25
    v_sub_f32 v59, v59, v24
    v_sub_f32 v203, v203, v25
    v_sub_f32 v60, v60, v24
    v_sub_f32 v204, v204, v25
    v_sub_f32 v61, v61, v24
    v_sub_f32 v205, v205, v25
    v_sub_f32 v62, v62, v24
    v_sub_f32 v206, v206, v25
    v_sub_f32 v63, v63, v24
    v_sub_f32 v207, v207, v25
    v_sub_f32 v64, v64, v24
    v_sub_f32 v208, v208, v25
    v_sub_f32 v65, v65, v24
    v_sub_f32 v209, v209, v25
    v_sub_f32 v66, v66, v24
    v_sub_f32 v210, v210, v25
    v_sub_f32 v67, v67, v24
    v_sub_f32 v211, v211, v25
    v_mul_f32 v14, v52, v52
    v_mul_f32 v15, v196, v196
    v_fma_f32 v14, v53, v53, v14
    v_fma_f32 v15, v197, v197, v15
    v_fma_f32 v14, v54, v54, v14
    v_fma_f32 v15, v198, v198, v15
    v_fma_f32 v14, v55, v55, v14
    v_fma_f32 v15, v199, v199, v15
    v_fma_f32 v14, v56, v56, v14
    v_fma_f32 v15, v200, v200, v15
    v_fma_f32 v14, v57, v57, v14
    v_fma_f32 v15, v201, v201, v15
    v_fma_f32 v14, v58, v58, v14
    v_fma_f32 v15, v202, v202, v15
    v_fma_f32 v14, v59, v59, v14
    v_fma_f32 v15, v203, v203, v15
    v_fma_f32 v14, v60, v60, v14
    v_fma_f32 v15, v204, v204, v15
    v_fma_f32 v14, v61, v61, v14
    v_fma_f32 v15, v205, v205, v15
    v_fma_f32 v14, v62, v62, v14
    v_fma_f32 v15, v206, v206, v15
    v_fma_f32 v14, v63, v63, v14
    v_fma_f32 v15, v207, v207, v15
    v_fma_f32 v14, v64, v64, v14
    v_fma_f32 v15, v208, v208, v15
    v_fma_f32 v14, v65, v65, v14
    v_fma_f32 v15, v209, v209, v15
    v_fma_f32 v14, v66, v66, v14
    v_fma_f32 v15, v210, v210, v15
    v_fma_f32 v14, v67, v67, v14
    v_fma_f32 v15, v211, v211, v15
    s_nop 1
    v_add_f32_dpp v14, v14, v14 row_ror:8 row_mask:0xf bank_mask:0xf
    v_add_f32_dpp v15, v15, v15 row_ror:8 row_mask:0xf bank_mask:0xf
    s_nop 0
    v_add_f32_dpp v14, v14, v14 row_ror:4 row_mask:0xf bank_mask:0xf
    v_add_f32_dpp v15, v15, v15 row_ror:4 row_mask:0xf bank_mask:0xf
    s_nop 0
    v_add_f32_dpp v14, v14, v14 row_ror:2 row_mask:0xf bank_mask:0xf
    v_add_f32_dpp v15, v15, v15 row_ror:2 row_mask:0xf bank_mask:0xf
    s_nop 0
    v_add_f32_dpp v14, v14, v14 row_ror:1 row_mask:0xf bank_mask:0xf
    v_add_f32_dpp v15, v15, v15 row_ror:1 row_mask:0xf bank_mask:0xf
    v_mov_b32 v16, v14
    v_mov_b32 v17, v15
    s_nop 1
    v_permlane16_swap_b32 v14, v16
    v_permlane16_swap_b32 v15, v17
    s_nop 0
    v_add_f32 v14, v14, v16
    v_add_f32 v15, v15, v17
    v_mov_b32 v16, v14
    v_mov_b32 v17, v15
    s_nop 1
    v_permlane32_swap_b32 v14, v16
    v_permlane32_swap_b32 v15, v17
    s_nop 0
    v_add_f32 v14, v14, v16
    v_add_f32 v15, v15, v17
    s_mov_b32 s74, 0
    s_mov_b32 s75, -1
    v_cndmask_b32_e64 v24, v24, v25, s[74:75]
    v_cndmask_b32_e64 v14, v14, v15, s[74:75]
    v_mul_f32 v14, 0x3a800000, v14
    v_cvt_pk_bf16_f32 v24, v24, v24
    v_and_b32 v24, 0xffff0000, v24
    v_cvt_pk_bf16_f32 v14, v14, v14
    v_and_b32 v14, 0xffff0000, v14
    v_add_f32 v14, 0x3727c5ac, v14
    v_cvt_pk_bf16_f32 v14, v14, v14
    v_and_b32 v14, 0xffff0000, v14
    v_sqrt_f32 v14, v14
    s_nop 0
    v_cvt_pk_bf16_f32 v14, v14, v14
    v_and_b32 v14, 0xffff0000, v14
    v_rcp_f32 v15, v14
    v_lshlrev_b32 v52, 16, v228
    v_and_b32 v53, 0xffff0000, v228
    v_lshlrev_b32 v54, 16, v229
    v_and_b32 v55, 0xffff0000, v229
    v_sub_f32 v52, v52, v24
    v_sub_f32 v53, v53, v24
    v_sub_f32 v54, v54, v24
    v_sub_f32 v55, v55, v24
    v_cvt_pk_bf16_f32 v52, v52, v52
    v_and_b32 v52, 0xffff0000, v52
    v_cvt_pk_bf16_f32 v53, v53, v53
    v_and_b32 v53, 0xffff0000, v53
    v_cvt_pk_bf16_f32 v54, v54, v54
    v_and_b32 v54, 0xffff0000, v54
    v_cvt_pk_bf16_f32 v55, v55, v55
    v_and_b32 v55, 0xffff0000, v55
    v_mul_f32 v56, v52, v15
    v_mul_f32 v57, v53, v15
    v_mul_f32 v58, v54, v15
    v_mul_f32 v59, v55, v15
    v_fma_f32 v52, -v56, v14, v52
    v_fma_f32 v53, -v57, v14, v53
    v_fma_f32 v54, -v58, v14, v54
    v_fma_f32 v55, -v59, v14, v55
    v_fma_f32 v56, v52, v15, v56
    v_fma_f32 v57, v53, v15, v57
    v_fma_f32 v58, v54, v15, v58
    v_fma_f32 v59, v55, v15, v59
    v_cvt_pk_bf16_f32 v56, v56, v56
    v_cvt_pk_bf16_f32 v57, v57, v57
    v_cvt_pk_bf16_f32 v58, v58, v58
    v_cvt_pk_bf16_f32 v59, v59, v59
    v_lshlrev_b32 v16, 3, v22
    v_lshrrev_b32 v17, 2, v21
    v_add_u32 v16, v16, v17
    v_lshlrev_b32 v16, 6, v16
    v_and_b32 v17, 3, v21
    v_lshlrev_b32 v17, 2, v17
    v_add_u32 v16, v16, v17
    ds_write_b32 v16, v56 offset:0
    ds_write_b32 v16, v57 offset:16
    ds_write_b32 v16, v58 offset:32
    ds_write_b32 v16, v59 offset:48
    v_mov_b32 v17, 0
    v_lshlrev_b32 v26, 2, v1
    ds_write_b32 v26, v17 offset:3584
    s_waitcnt lgkmcnt(0)
    ds_read_b128 v[212:215], v6 offset:0
    ds_read_b128 v[216:219], v6 offset:64
    ds_read_b128 v[220:223], v6 offset:128
    ds_read_b128 v[224:227], v6 offset:192
    ds_read_b128 v[228:231], v6 offset:256
    ds_read_b128 v[232:235], v6 offset:320
    ds_read_b128 v[236:239], v6 offset:384
    ds_read_b128 v[240:243], v6 offset:448
    s_waitcnt lgkmcnt(0)
    v_and_b32 v44, v212, v32
    v_and_b32 v45, v212, v33
    v_and_b32 v46, v212, v34
    v_and_b32 v47, v212, v35
    v_and_b32 v48, v213, v32
    v_and_b32 v49, v213, v33
    v_and_b32 v50, v213, v34
    v_and_b32 v51, v213, v35
    s_waitcnt vmcnt(30)
    v_mfma_f32_16x16x32_bf16 v[52:55], v[68:71], v[44:47], 0
    v_and_b32 v44, v214, v32
    v_and_b32 v45, v214, v33
    v_and_b32 v46, v214, v34
    v_and_b32 v47, v214, v35
    v_mfma_f32_16x16x32_bf16 v[52:55], v[72:75], v[48:51], v[52:55]
    v_and_b32 v48, v215, v32
    v_and_b32 v49, v215, v33
    v_and_b32 v50, v215, v34
    v_and_b32 v51, v215, v35
    s_waitcnt vmcnt(28)
    v_mfma_f32_16x16x32_bf16 v[52:55], v[76:79], v[44:47], v[52:55]
    v_and_b32 v44, v216, v32
    v_and_b32 v45, v216, v33
    v_and_b32 v46, v216, v34
    v_and_b32 v47, v216, v35
    v_mfma_f32_16x16x32_bf16 v[52:55], v[80:83], v[48:51], v[52:55]
    v_and_b32 v48, v217, v32
    v_and_b32 v49, v217, v33
    v_and_b32 v50, v217, v34
    v_and_b32 v51, v217, v35
    s_waitcnt vmcnt(26)
    v_mfma_f32_16x16x32_bf16 v[52:55], v[84:87], v[44:47], v[52:55]
    v_and_b32 v44, v218, v32
    v_and_b32 v45, v218, v33
    v_and_b32 v46, v218, v34
    v_and_b32 v47, v218, v35
    v_mfma_f32_16x16x32_bf16 v[52:55], v[88:91], v[48:51], v[52:55]
    v_and_b32 v48, v219, v32
    v_and_b32 v49, v219, v33
    v_and_b32 v50, v219, v34
    v_and_b32 v51, v219, v35
    s_waitcnt vmcnt(24)
    v_mfma_f32_16x16x32_bf16 v[52:55], v[92:95], v[44:47], v[52:55]
    v_and_b32 v44, v220, v32
    v_and_b32 v45, v220, v33
    v_and_b32 v46, v220, v34
    v_and_b32 v47, v220, v35
    v_mfma_f32_16x16x32_bf16 v[52:55], v[96:99], v[48:51], v[52:55]
    v_and_b32 v48, v221, v32
    v_and_b32 v49, v221, v33
    v_and_b32 v50, v221, v34
    v_and_b32 v51, v221, v35
    s_waitcnt vmcnt(22)
    v_mfma_f32_16x16x32_bf16 v[52:55], v[100:103], v[44:47], v[52:55]
    v_and_b32 v44, v222, v32
    v_and_b32 v45, v222, v33
    v_and_b32 v46, v222, v34
    v_and_b32 v47, v222, v35
    v_mfma_f32_16x16x32_bf16 v[52:55], v[104:107], v[48:51], v[52:55]
    v_and_b32 v48, v223, v32
    v_and_b32 v49, v223, v33
    v_and_b32 v50, v223, v34
    v_and_b32 v51, v223, v35
    s_waitcnt vmcnt(20)
    v_mfma_f32_16x16x32_bf16 v[52:55], v[108:111], v[44:47], v[52:55]
    v_and_b32 v44, v224, v32
    v_and_b32 v45, v224, v33
    v_and_b32 v46, v224, v34
    v_and_b32 v47, v224, v35
    v_mfma_f32_16x16x32_bf16 v[52:55], v[112:115], v[48:51], v[52:55]
    v_and_b32 v48, v225, v32
    v_and_b32 v49, v225, v33
    v_and_b32 v50, v225, v34
    v_and_b32 v51, v225, v35
    s_waitcnt vmcnt(18)
    v_mfma_f32_16x16x32_bf16 v[52:55], v[116:119], v[44:47], v[52:55]
    v_and_b32 v44, v226, v32
    v_and_b32 v45, v226, v33
    v_and_b32 v46, v226, v34
    v_and_b32 v47, v226, v35
    v_mfma_f32_16x16x32_bf16 v[52:55], v[120:123], v[48:51], v[52:55]
    v_and_b32 v48, v227, v32
    v_and_b32 v49, v227, v33
    v_and_b32 v50, v227, v34
    v_and_b32 v51, v227, v35
    s_waitcnt vmcnt(16)
    v_mfma_f32_16x16x32_bf16 v[52:55], v[124:127], v[44:47], v[52:55]
    v_and_b32 v44, v228, v32
    v_and_b32 v45, v228, v33
    v_and_b32 v46, v228, v34
    v_and_b32 v47, v228, v35
    v_mfma_f32_16x16x32_bf16 v[52:55], v[128:131], v[48:51], v[52:55]
    v_and_b32 v48, v229, v32
    v_and_b32 v49, v229, v33
    v_and_b32 v50, v229, v34
    v_and_b32 v51, v229, v35
    s_waitcnt vmcnt(14)
    v_mfma_f32_16x16x32_bf16 v[52:55], v[132:135], v[44:47], v[52:55]
    v_and_b32 v44, v230, v32
    v_and_b32 v45, v230, v33
    v_and_b32 v46, v230, v34
    v_and_b32 v47, v230, v35
    v_mfma_f32_16x16x32_bf16 v[52:55], v[136:139], v[48:51], v[52:55]
    v_and_b32 v48, v231, v32
    v_and_b32 v49, v231, v33
    v_and_b32 v50, v231, v34
    v_and_b32 v51, v231, v35
    s_waitcnt vmcnt(12)
    v_mfma_f32_16x16x32_bf16 v[52:55], v[140:143], v[44:47], v[52:55]
    v_and_b32 v44, v232, v32
    v_and_b32 v45, v232, v33
    v_and_b32 v46, v232, v34
    v_and_b32 v47, v232, v35
    v_mfma_f32_16x16x32_bf16 v[52:55], v[144:147], v[48:51], v[52:55]
    v_and_b32 v48, v233, v32
    v_and_b32 v49, v233, v33
    v_and_b32 v50, v233, v34
    v_and_b32 v51, v233, v35
    s_waitcnt vmcnt(10)
    v_mfma_f32_16x16x32_bf16 v[52:55], v[148:151], v[44:47], v[52:55]
    v_and_b32 v44, v234, v32
    v_and_b32 v45, v234, v33
    v_and_b32 v46, v234, v34
    v_and_b32 v47, v234, v35
    v_mfma_f32_16x16x32_bf16 v[52:55], v[152:155], v[48:51], v[52:55]
    v_and_b32 v48, v235, v32
    v_and_b32 v49, v235, v33
    v_and_b32 v50, v235, v34
    v_and_b32 v51, v235, v35
    s_waitcnt vmcnt(8)
    v_mfma_f32_16x16x32_bf16 v[52:55], v[156:159], v[44:47], v[52:55]
    v_and_b32 v44, v236, v32
    v_and_b32 v45, v236, v33
    v_and_b32 v46, v236, v34
    v_and_b32 v47, v236, v35
    v_mfma_f32_16x16x32_bf16 v[52:55], v[160:163], v[48:51], v[52:55]
    v_and_b32 v48, v237, v32
    v_and_b32 v49, v237, v33
    v_and_b32 v50, v237, v34
    v_and_b32 v51, v237, v35
    s_waitcnt vmcnt(6)
    v_mfma_f32_16x16x32_bf16 v[52:55], v[164:167], v[44:47], v[52:55]
    v_and_b32 v44, v238, v32
    v_and_b32 v45, v238, v33
    v_and_b32 v46, v238, v34
    v_and_b32 v47, v238, v35
    v_mfma_f32_16x16x32_bf16 v[52:55], v[168:171], v[48:51], v[52:55]
    v_and_b32 v48, v239, v32
    v_and_b32 v49, v239, v33
    v_and_b32 v50, v239, v34
    v_and_b32 v51, v239, v35
    s_waitcnt vmcnt(4)
    v_mfma_f32_16x16x32_bf16 v[52:55], v[172:175], v[44:47], v[52:55]
    v_and_b32 v44, v240, v32
    v_and_b32 v45, v240, v33
    v_and_b32 v46, v240, v34
    v_and_b32 v47, v240, v35
    v_mfma_f32_16x16x32_bf16 v[52:55], v[176:179], v[48:51], v[52:55]
    v_and_b32 v48, v241, v32
    v_and_b32 v49, v241, v33
    v_and_b32 v50, v241, v34
    v_and_b32 v51, v241, v35
    s_waitcnt vmcnt(2)
    v_mfma_f32_16x16x32_bf16 v[52:55], v[180:183], v[44:47], v[52:55]
    v_and_b32 v44, v242, v32
    v_and_b32 v45, v242, v33
    v_and_b32 v46, v242, v34
    v_and_b32 v47, v242, v35
    v_mfma_f32_16x16x32_bf16 v[52:55], v[184:187], v[48:51], v[52:55]
    v_and_b32 v48, v243, v32
    v_and_b32 v49, v243, v33
    v_and_b32 v50, v243, v34
    v_and_b32 v51, v243, v35
    s_waitcnt vmcnt(0)
    v_mfma_f32_16x16x32_bf16 v[52:55], v[188:191], v[44:47], v[52:55]
    s_nop 1
    v_mfma_f32_16x16x32_bf16 v[52:55], v[192:195], v[48:51], v[52:55]
    s_waitcnt vmcnt(0)
    v_bfe_u32 v16, v1, 3, 1
    v_lshlrev_b32 v16, 6, v16
    v_and_b32 v17, 0x30, v1
    v_add_u32 v16, v16, v17
    v_and_b32 v17, 7, v1
    v_add_u32 v16, v16, v17
    v_lshlrev_b32 v16, 4, v16
    v_mov_b32 v212, v52
    v_mov_b32 v213, v244
    v_mov_b32 v214, v53
    v_mov_b32 v215, v245
    buffer_store_dwordx4 v[212:215], v16, s[44:47], s64 offen offset:0 sc0 sc1
    v_mov_b32 v216, v54
    v_mov_b32 v217, v244
    v_mov_b32 v218, v55
    v_mov_b32 v219, v245
    buffer_store_dwordx4 v[216:219], v16, s[44:47], s64 offen offset:128 sc0 sc1
    buffer_load_dwordx4 v[148:151], v4, s[24:27], s101 offen nt
    s_add_u32 s63, s101, 28672
    buffer_load_dwordx4 v[152:155], v4, s[24:27], s63 offen nt
    s_add_u32 s63, s101, 57344
    buffer_load_dwordx4 v[156:159], v4, s[24:27], s63 offen nt
    s_add_u32 s63, s101, 86016
    buffer_load_dwordx4 v[160:163], v4, s[24:27], s63 offen nt
    buffer_load_dwordx4 v[164:167], v4, s[28:31], s101 offen nt
    s_add_u32 s63, s101, 28672
    buffer_load_dwordx4 v[168:171], v4, s[28:31], s63 offen nt
    s_add_u32 s63, s101, 57344
    buffer_load_dwordx4 v[172:175], v4, s[28:31], s63 offen nt
    s_add_u32 s63, s101, 86016
    buffer_load_dwordx4 v[176:179], v4, s[28:31], s63 offen nt
    s_lshl_b32 s57, s6, 10
    s_add_u32 s57, s57, 0
    v_lshlrev_b32 v232, 4, v1
    v_add_u32 v232, s57, v232
    s_add_u32 s63, s65, 0
    buffer_load_dwordx4 v[180:183], v232, s[44:47], s63 offen sc1
    s_add_u32 s63, s65, 16896
    buffer_load_dwordx4 v[184:187], v232, s[44:47], s63 offen sc1
    s_add_u32 s63, s65, 33792
    buffer_load_dwordx4 v[188:191], v232, s[44:47], s63 offen sc1
    s_add_u32 s63, s65, 50688
    buffer_load_dwordx4 v[192:195], v232, s[44:47], s63 offen sc1
    s_add_u32 s63, s65, 67584
    buffer_load_dwordx4 v[196:199], v232, s[44:47], s63 offen sc1
    s_add_u32 s63, s65, 84480
    buffer_load_dwordx4 v[200:203], v232, s[44:47], s63 offen sc1
    s_add_u32 s63, s65, 101376
    buffer_load_dwordx4 v[204:207], v232, s[44:47], s63 offen sc1
    s_add_u32 s63, s65, 118272
    buffer_load_dwordx4 v[208:211], v232, s[44:47], s63 offen sc1
    s_waitcnt vmcnt(0)
    s_mov_b32 s66, 200000
L_chk_5:
    v_cmpx_eq_u32 vcc, v181, v244
    v_cmpx_eq_u32 vcc, v183, v245
    v_cmpx_eq_u32 vcc, v185, v244
    v_cmpx_eq_u32 vcc, v187, v245
    v_cmpx_eq_u32 vcc, v189, v244
    v_cmpx_eq_u32 vcc, v191, v245
    v_cmpx_eq_u32 vcc, v193, v244
    v_cmpx_eq_u32 vcc, v195, v245
    v_cmpx_eq_u32 vcc, v197, v244
    v_cmpx_eq_u32 vcc, v199, v245
    v_cmpx_eq_u32 vcc, v201, v244
    v_cmpx_eq_u32 vcc, v203, v245
    v_cmpx_eq_u32 vcc, v205, v244
    v_cmpx_eq_u32 vcc, v207, v245
    v_cmpx_eq_u32 vcc, v209, v244
    v_cmpx_eq_u32 vcc, v211, v245
    s_nop 1
    s_mov_b64 s[98:99], exec
    s_mov_b64 exec, -1
    s_cmp_eq_u64 s[98:99], -1
    s_cbranch_scc1 L_ok_6
    s_sub_u32 s66, s66, 1
    s_cbranch_scc1 L_ok_6
    s_add_u32 s63, s65, 0
    buffer_load_dwordx4 v[180:183], v232, s[44:47], s63 offen sc1
    s_add_u32 s63, s65, 16896
    buffer_load_dwordx4 v[184:187], v232, s[44:47], s63 offen sc1
    s_add_u32 s63, s65, 33792
    buffer_load_dwordx4 v[188:191], v232, s[44:47], s63 offen sc1
    s_add_u32 s63, s65, 50688
    buffer_load_dwordx4 v[192:195], v232, s[44:47], s63 offen sc1
    s_add_u32 s63, s65, 67584
    buffer_load_dwordx4 v[196:199], v232, s[44:47], s63 offen sc1
    s_add_u32 s63, s65, 84480
    buffer_load_dwordx4 v[200:203], v232, s[44:47], s63 offen sc1
    s_add_u32 s63, s65, 101376
    buffer_load_dwordx4 v[204:207], v232, s[44:47], s63 offen sc1
    s_add_u32 s63, s65, 118272
    buffer_load_dwordx4 v[208:211], v232, s[44:47], s63 offen sc1
    s_waitcnt vmcnt(0)
    s_branch L_chk_5
L_ok_6:
    v_add_f32 v180, v180, v184
    v_add_f32 v188, v188, v192
    v_add_f32 v196, v196, v200
    v_add_f32 v204, v204, v208
    v_add_f32 v180, v180, v188
    v_add_f32 v196, v196, v204
    v_add_f32 v220, v180, v196
    v_add_f32 v182, v182, v186
    v_add_f32 v190, v190, v194
    v_add_f32 v198, v198, v202
    v_add_f32 v206, v206, v210
    v_add_f32 v182, v182, v190
    v_add_f32 v198, v198, v206
    v_add_f32 v221, v182, v198
    v_cvt_pk_bf16_f32 v220, v220, v221
    v_and_b32 v221, 0x38, v1
    v_lshlrev_b32 v221, 1, v221
    v_and_b32 v222, 7, v1
    v_add_u32 v221, v221, v222
    v_lshlrev_b32 v221, 1, v221
    ds_write_b16 v221, v220 offset:3072
    ds_write_b16_d16_hi v221, v220 offset:3088
    s_waitcnt lgkmcnt(0)
L_w0c_4:
    s_barrier
    s_cmp_lg_u32 s3, 0
    s_cbranch_scc1 L_w0r_7
    s_mov_b32 s54, s84
    buffer_load_dwordx4 v[68:71], v2, s[12:15], s54 offen offset:0 nt
    buffer_load_dwordx4 v[72:75], v2, s[12:15], s54 offen offset:1024 nt
    buffer_load_dwordx4 v[76:79], v2, s[12:15], s54 offen offset:2048 nt
    buffer_load_dwordx4 v[80:83], v2, s[12:15], s54 offen offset:3072 nt
    s_add_u32 s54, s54, 32768
    buffer_load_dwordx4 v[84:87], v2, s[12:15], s54 offen offset:0 nt
    buffer_load_dwordx4 v[88:91], v2, s[12:15], s54 offen offset:1024 nt
    buffer_load_dwordx4 v[92:95], v2, s[12:15], s54 offen offset:2048 nt
    buffer_load_dwordx4 v[96:99], v2, s[12:15], s54 offen offset:3072 nt
L_w0r_7:
    s_add_u32 s54, s54, 32768
    buffer_load_dwordx4 v[100:103], v2, s[12:15], s54 offen offset:0 nt
    buffer_load_dwordx4 v[104:107], v2, s[12:15], s54 offen offset:1024 nt
    buffer_load_dwordx4 v[108:111], v2, s[12:15], s54 offen offset:2048 nt
    buffer_load_dwordx4 v[112:115], v2, s[12:15], s54 offen offset:3072 nt
    s_add_u32 s54, s54, 32768
    buffer_load_dwordx4 v[116:119], v2, s[12:15], s54 offen offset:0 nt
    buffer_load_dwordx4 v[120:123], v2, s[12:15], s54 offen offset:1024 nt
    buffer_load_dwordx4 v[124:127], v2, s[12:15], s54 offen offset:2048 nt
    buffer_load_dwordx4 v[128:131], v2, s[12:15], s54 offen offset:3072 nt
    v_and_b32 v14, 15, v1
    v_lshlrev_b32 v14, 4, v14
    ds_read_b128 v[36:39], v14 offset:3072
    s_waitcnt vmcnt(20)
    s_cmp_eq_u32 s3, 0
    s_cbranch_scc1 L_tag_8
    v_add_u32 v244, 1, v244
    v_add_u32 v245, 1, v245
L_tag_8:
    ds_read_b128 v[212:215], v6 offset:0
    s_waitcnt lgkmcnt(0)
    v_and_b32 v44, v212, v32
    v_and_b32 v45, v212, v33
    v_and_b32 v46, v212, v34
    v_and_b32 v47, v212, v35
    v_and_b32 v48, v213, v32
    v_and_b32 v49, v213, v33
    v_and_b32 v50, v213, v34
    v_and_b32 v51, v213, v35
    v_mfma_f32_16x16x32_bf16 v[216:219], v[148:151], v[44:47], 0
    v_and_b32 v44, v214, v32
    v_and_b32 v45, v214, v33
    v_and_b32 v46, v214, v34
    v_and_b32 v47, v214, v35
    v_mfma_f32_16x16x32_bf16 v[216:219], v[152:155], v[48:51], v[216:219]
    v_and_b32 v48, v215, v32
    v_and_b32 v49, v215, v33
    v_and_b32 v50, v215, v34
    v_and_b32 v51, v215, v35
    v_mfma_f32_16x16x32_bf16 v[216:219], v[156:159], v[44:47], v[216:219]
    s_nop 1
    v_mfma_f32_16x16x32_bf16 v[216:219], v[160:163], v[48:51], v[216:219]
    s_nop 7
    ds_write_b128 v7, v[216:219] offset:12288
    s_waitcnt vmcnt(16)
    ds_read_b128 v[212:215], v6 offset:0
    s_waitcnt lgkmcnt(0)
    v_and_b32 v44, v212, v32
    v_and_b32 v45, v212, v33
    v_and_b32 v46, v212, v34
    v_and_b32 v47, v212, v35
    v_and_b32 v48, v213, v32
    v_and_b32 v49, v213, v33
    v_and_b32 v50, v213, v34
    v_and_b32 v51, v213, v35
    v_mfma_f32_16x16x32_bf16 v[216:219], v[164:167], v[44:47], 0
    v_and_b32 v44, v214, v32
    v_and_b32 v45, v214, v33
    v_and_b32 v46, v214, v34
    v_and_b32 v47, v214, v35
    v_mfma_f32_16x16x32_bf16 v[216:219], v[168:171], v[48:51], v[216:219]
    v_and_b32 v48, v215, v32
    v_and_b32 v49, v215, v33
    v_and_b32 v50, v215, v34
    v_and_b32 v51, v215, v35
    v_mfma_f32_16x16x32_bf16 v[216:219], v[172:175], v[44:47], v[216:219]
    s_nop 1
    v_mfma_f32_16x16x32_bf16 v[216:219], v[176:179], v[48:51], v[216:219]
    s_nop 7
    ds_write_b128 v7, v[216:219] offset:20480
    s_waitcnt lgkmcnt(0)
    v_mov_b32 v14, 0
    v_mov_b32 v15, 1
    s_mov_b64 exec, 1
    ds_add_u32 v14, v15 offset:3584
    s_mov_b64 exec, -1
L_STREAM:
    s_mov_b32 s86, 0
    s_add_u32 s84, s83, 131072
    s_waitcnt vmcnt(15)
    v_dot2_f32_bf16 v52, v68, v36, 0
    v_dot2_f32_bf16 v52, v69, v37, v52
    v_dot2_f32_bf16 v52, v70, v38, v52
    v_dot2_f32_bf16 v52, v71, v39, v52
    s_waitcnt vmcnt(14)
    v_dot2_f32_bf16 v53, v72, v36, 0
    v_dot2_f32_bf16 v53, v73, v37, v53
    v_dot2_f32_bf16 v53, v74, v38, v53
    v_dot2_f32_bf16 v53, v75, v39, v53
    s_waitcnt vmcnt(13)
    v_dot2_f32_bf16 v54, v76, v36, 0
    v_dot2_f32_bf16 v54, v77, v37, v54
    v_dot2_f32_bf16 v54, v78, v38, v54
    v_dot2_f32_bf16 v54, v79, v39, v54
    s_waitcnt vmcnt(12)
    v_dot2_f32_bf16 v55, v80, v36, 0
    v_dot2_f32_bf16 v55, v81, v37, v55
    v_dot2_f32_bf16 v55, v82, v38, v55
    v_dot2_f32_bf16 v55, v83, v39, v55
    s_waitcnt vmcnt(11)
    v_dot2_f32_bf16 v56, v84, v36, 0
    v_dot2_f32_bf16 v56, v85, v37, v56
    v_dot2_f32_bf16 v56, v86, v38, v56
    v_dot2_f32_bf16 v56, v87, v39, v56
    s_waitcnt vmcnt(10)
    v_dot2_f32_bf16 v57, v88, v36, 0
    v_dot2_f32_bf16 v57, v89, v37, v57
    v_dot2_f32_bf16 v57, v90, v38, v57
    v_dot2_f32_bf16 v57, v91, v39, v57
    s_waitcnt vmcnt(9)
    v_dot2_f32_bf16 v58, v92, v36, 0
    v_dot2_f32_bf16 v58, v93, v37, v58
    v_dot2_f32_bf16 v58, v94, v38, v58
    v_dot2_f32_bf16 v58, v95, v39, v58
    s_waitcnt vmcnt(8)
    v_dot2_f32_bf16 v59, v96, v36, 0
    v_dot2_f32_bf16 v59, v97, v37, v59
    v_dot2_f32_bf16 v59, v98, v38, v59
    v_dot2_f32_bf16 v59, v99, v39, v59
    s_waitcnt vmcnt(7)
    v_dot2_f32_bf16 v60, v100, v36, 0
    v_dot2_f32_bf16 v60, v101, v37, v60
    v_dot2_f32_bf16 v60, v102, v38, v60
    v_dot2_f32_bf16 v60, v103, v39, v60
    s_waitcnt vmcnt(6)
    v_dot2_f32_bf16 v61, v104, v36, 0
    v_dot2_f32_bf16 v61, v105, v37, v61
    v_dot2_f32_bf16 v61, v106, v38, v61
    v_dot2_f32_bf16 v61, v107, v39, v61
    s_waitcnt vmcnt(5)
    v_dot2_f32_bf16 v62, v108, v36, 0
    v_dot2_f32_bf16 v62, v109, v37, v62
    v_dot2_f32_bf16 v62, v110, v38, v62
    v_dot2_f32_bf16 v62, v111, v39, v62
    s_waitcnt vmcnt(4)
    v_dot2_f32_bf16 v63, v112, v36, 0
    v_dot2_f32_bf16 v63, v113, v37, v63
    v_dot2_f32_bf16 v63, v114, v38, v63
    v_dot2_f32_bf16 v63, v115, v39, v63
    s_waitcnt vmcnt(3)
    v_dot2_f32_bf16 v64, v116, v36, 0
    v_dot2_f32_bf16 v64, v117, v37, v64
    v_dot2_f32_bf16 v64, v118, v38, v64
    v_dot2_f32_bf16 v64, v119, v39, v64
    s_waitcnt vmcnt(2)
    s_mov_b32 s55, s83
    buffer_load_dwordx4 v[68:71], v2, s[16:19], s55 offen offset:0 nt
    v_dot2_f32_bf16 v65, v120, v36, 0
    v_dot2_f32_bf16 v65, v121, v37, v65
    v_dot2_f32_bf16 v65, v122, v38, v65
    v_dot2_f32_bf16 v65, v123, v39, v65
    s_waitcnt vmcnt(2)
    buffer_load_dwordx4 v[72:75], v2, s[16:19], s55 offen offset:1024 nt
    v_dot2_f32_bf16 v66, v124, v36, 0
    v_dot2_f32_bf16 v66, v125, v37, v66
    v_dot2_f32_bf16 v66, v126, v38, v66
    v_dot2_f32_bf16 v66, v127, v39, v66
    s_waitcnt vmcnt(2)
    buffer_load_dwordx4 v[76:79], v2, s[16:19], s55 offen offset:2048 nt
    v_dot2_f32_bf16 v67, v128, v36, 0
    v_dot2_f32_bf16 v67, v129, v37, v67
    v_dot2_f32_bf16 v67, v130, v38, v67
    v_dot2_f32_bf16 v67, v131, v39, v67
    s_nop 2
    v_add_f32_dpp v52, v52, v52 row_ror:8 row_mask:0xf bank_mask:0x3
    v_add_f32_dpp v53, v53, v53 row_ror:8 row_mask:0xf bank_mask:0x3
    v_add_f32_dpp v54, v54, v54 row_ror:8 row_mask:0xf bank_mask:0x3
    v_add_f32_dpp v55, v55, v55 row_ror:8 row_mask:0xf bank_mask:0x3
    v_add_f32_dpp v56, v56, v56 row_ror:8 row_mask:0xf bank_mask:0x3
    v_add_f32_dpp v57, v57, v57 row_ror:8 row_mask:0xf bank_mask:0x3
    v_add_f32_dpp v58, v58, v58 row_ror:8 row_mask:0xf bank_mask:0x3
    v_add_f32_dpp v59, v59, v59 row_ror:8 row_mask:0xf bank_mask:0x3
    v_add_f32_dpp v52, v60, v60 row_ror:8 row_mask:0xf bank_mask:0xc
    v_add_f32_dpp v53, v61, v61 row_ror:8 row_mask:0xf bank_mask:0xc
    v_add_f32_dpp v54, v62, v62 row_ror:8 row_mask:0xf bank_mask:0xc
    v_add_f32_dpp v55, v63, v63 row_ror:8 row_mask:0xf bank_mask:0xc
    v_add_f32_dpp v56, v64, v64 row_ror:8 row_mask:0xf bank_mask:0xc
    v_add_f32_dpp v57, v65, v65 row_ror:8 row_mask:0xf bank_mask:0xc
    v_add_f32_dpp v58, v66, v66 row_ror:8 row_mask:0xf bank_mask:0xc
    v_add_f32_dpp v59, v67, v67 row_ror:8 row_mask:0xf bank_mask:0xc
    v_add_f32_dpp v52, v52, v52 row_ror:12 row_mask:0xf bank_mask:0x5
    v_add_f32_dpp v53, v53, v53 row_ror:12 row_mask:0xf bank_mask:0x5
    v_add_f32_dpp v54, v54, v54 row_ror:12 row_mask:0xf bank_mask:0x5
    v_add_f32_dpp v55, v55, v55 row_ror:12 row_mask:0xf bank_mask:0x5
    v_add_f32_dpp v52, v56, v56 row_ror:4 row_mask:0xf bank_mask:0xa
    v_add_f32_dpp v53, v57, v57 row_ror:4 row_mask:0xf bank_mask:0xa
    v_add_f32_dpp v54, v58, v58 row_ror:4 row_mask:0xf bank_mask:0xa
    v_add_f32_dpp v55, v59, v59 row_ror:4 row_mask:0xf bank_mask:0xa
    v_add_f32_dpp v60, v52, v52 quad_perm:[2,3,0,1] row_mask:0xf bank_mask:0xf
    v_add_f32_dpp v61, v53, v53 quad_perm:[2,3,0,1] row_mask:0xf bank_mask:0xf
    v_add_f32_dpp v62, v54, v54 quad_perm:[2,3,0,1] row_mask:0xf bank_mask:0xf
    v_add_f32_dpp v63, v55, v55 quad_perm:[2,3,0,1] row_mask:0xf bank_mask:0xf
    v_cndmask_b32_e64 v52, v60, v62, s[96:97]
    v_cndmask_b32_e64 v53, v61, v63, s[96:97]
    s_nop 0
    v_add_f32_dpp v60, v52, v52 quad_perm:[1,0,3,2] row_mask:0xf bank_mask:0xf
    v_add_f32_dpp v61, v53, v53 quad_perm:[1,0,3,2] row_mask:0xf bank_mask:0xf
    v_cndmask_b32_e64 v14, v60, v61, s[94:95]
    v_cvt_pk_bf16_f32 v14, v14, v14
    v_and_b32 v14, 0xffff0000, v14
    v_mul_f32 v14, 0x3db504f3, v14
    v_cvt_pk_bf16_f32 v14, v14, v14
    v_and_b32 v14, 0xffff0000, v14
    v_mov_b32 v15, v14
    s_nop 1
    v_max_f32_dpp v15, v15, v15 row_ror:8 row_mask:0xf bank_mask:0xf
    s_nop 1
    v_max_f32_dpp v15, v15, v15 row_ror:4 row_mask:0xf bank_mask:0xf
    s_nop 1
    v_max_f32_dpp v15, v15, v15 row_ror:2 row_mask:0xf bank_mask:0xf
    s_nop 1
    v_max_f32_dpp v15, v15, v15 row_ror:1 row_mask:0xf bank_mask:0xf
    v_mov_b32 v16, v15
    s_nop 1
    v_permlane16_swap_b32 v15, v16
    s_nop 0
    v_max_f32 v15, v15, v16
    v_mov_b32 v16, v15
    s_nop 1
    v_permlane32_swap_b32 v15, v16
    s_nop 0
    v_max_f32 v15, v15, v16
    v_max_f32 v15, v15, v11
    v_sub_f32 v16, v11, v15
    v_sub_f32 v14, v14, v15
    v_mul_f32 v16, 0x3fb8aa3b, v16
    v_mul_f32 v14, 0x3fb8aa3b, v14
    v_exp_f32 v16, v16
    v_exp_f32 v14, v14
    v_mov_b32 v11, v15
    v_cvt_pk_bf16_f32 v13, v14, v14
    v_fma_f32 v12, v12, v16, v14
    v_mul_f32 v40, v16, v40
    v_mul_f32 v41, v16, v41
    v_mul_f32 v42, v16, v42
    v_mul_f32 v43, v16, v43
    v_and_b32_dpp v44, v13, v32 row_newbcast:0 row_mask:0xf bank_mask:0xf
    v_and_b32_dpp v45, v13, v33 row_newbcast:0 row_mask:0xf bank_mask:0xf
    v_and_b32_dpp v46, v13, v34 row_newbcast:0 row_mask:0xf bank_mask:0xf
    v_and_b32_dpp v47, v13, v35 row_newbcast:0 row_mask:0xf bank_mask:0xf
    s_cmp_ge_u32 s3, 4
    s_cbranch_scc1 L_skipB_9
    s_cmp_ge_u32 s4, 28
    s_cbranch_scc1 L_skipB_9
    v_mov_b32 v212, 0
L_cnt_10:
    ds_read_b32 v213, v212 offset:3584
    s_waitcnt lgkmcnt(0)
    v_readfirstlane_b32 s57, v213
    s_nop 0
    s_cmp_lt_u32 s57, 8
    s_cbranch_scc1 L_cnt_10
    s_cmp_ge_u32 s3, 2
    s_cselect_b32 s57, 8192, 0
    s_add_u32 s57, s57, 12288
    v_add_u32 v14, s57, v8
    v_add_u32 v240, 16, v14
    ds_read2st64_b32 v[224:225], v14 offset0:0 offset1:4
    ds_read2st64_b32 v[226:227], v14 offset0:8 offset1:12
    ds_read2st64_b32 v[228:229], v14 offset0:16 offset1:20
    ds_read2st64_b32 v[230:231], v14 offset0:24 offset1:28
    ds_read2st64_b32 v[232:233], v240 offset0:0 offset1:4
    ds_read2st64_b32 v[234:235], v240 offset0:8 offset1:12
    ds_read2st64_b32 v[236:237], v240 offset0:16 offset1:20
    ds_read2st64_b32 v[238:239], v240 offset0:24 offset1:28
    s_waitcnt lgkmcnt(0)
    v_add_f32 v224, v224, v225
    v_add_f32 v226, v226, v227
    v_add_f32 v228, v228, v229
    v_add_f32 v230, v230, v231
    v_add_f32 v224, v224, v226
    v_add_f32 v228, v228, v230
    v_add_f32 v220, v224, v228
    v_add_f32 v232, v232, v233
    v_add_f32 v234, v234, v235
    v_add_f32 v236, v236, v237
    v_add_f32 v238, v238, v239
    v_add_f32 v232, v232, v234
    v_add_f32 v236, v236, v238
    v_add_f32 v221, v232, v236
    s_lshl_b32 s58, s3, 9
    s_add_u32 s58, s58, 2048
    v_lshlrev_b32 v15, 3, v1
    v_add_u32 v15, s58, v15
    buffer_store_dwordx2 v[220:221], v15, s[44:47], s64 offen sc0 sc1 nt
L_skipB_9:
    s_waitcnt vmcnt(2)
    buffer_load_dwordx4 v[80:83], v2, s[16:19], s55 offen offset:3072 nt
    v_and_b32_dpp v48, v13, v32 row_newbcast:1 row_mask:0xf bank_mask:0xf
    v_and_b32_dpp v49, v13, v33 row_newbcast:1 row_mask:0xf bank_mask:0xf
    v_and_b32_dpp v50, v13, v34 row_newbcast:1 row_mask:0xf bank_mask:0xf
    v_and_b32_dpp v51, v13, v35 row_newbcast:1 row_mask:0xf bank_mask:0xf
    v_mfma_f32_16x16x32_bf16 v[40:43], v[68:71], v[44:47], v[40:43]
    s_waitcnt vmcnt(2)
    s_add_u32 s55, s55, 32768
    buffer_load_dwordx4 v[84:87], v2, s[16:19], s55 offen offset:0 nt
    v_and_b32_dpp v44, v13, v32 row_newbcast:2 row_mask:0xf bank_mask:0xf
    v_and_b32_dpp v45, v13, v33 row_newbcast:2 row_mask:0xf bank_mask:0xf
    v_and_b32_dpp v46, v13, v34 row_newbcast:2 row_mask:0xf bank_mask:0xf
    v_and_b32_dpp v47, v13, v35 row_newbcast:2 row_mask:0xf bank_mask:0xf
    v_mfma_f32_16x16x32_bf16 v[40:43], v[72:75], v[48:51], v[40:43]
    s_waitcnt vmcnt(2)
    buffer_load_dwordx4 v[88:91], v2, s[16:19], s55 offen offset:1024 nt
    v_and_b32_dpp v48, v13, v32 row_newbcast:3 row_mask:0xf bank_mask:0xf
    v_and_b32_dpp v49, v13, v33 row_newbcast:3 row_mask:0xf bank_mask:0xf
    v_and_b32_dpp v50, v13, v34 row_newbcast:3 row_mask:0xf bank_mask:0xf
    v_and_b32_dpp v51, v13, v35 row_newbcast:3 row_mask:0xf bank_mask:0xf
    v_mfma_f32_16x16x32_bf16 v[40:43], v[76:79], v[44:47], v[40:43]
    s_waitcnt vmcnt(2)
    buffer_load_dwordx4 v[92:95], v2, s[16:19], s55 offen offset:2048 nt
    v_and_b32_dpp v44, v13, v32 row_newbcast:4 row_mask:0xf bank_mask:0xf
    v_and_b32_dpp v45, v13, v33 row_newbcast:4 row_mask:0xf bank_mask:0xf
    v_and_b32_dpp v46, v13, v34 row_newbcast:4 row_mask:0xf bank_mask:0xf
    v_and_b32_dpp v47, v13, v35 row_newbcast:4 row_mask:0xf bank_mask:0xf
    v_mfma_f32_16x16x32_bf16 v[40:43], v[80:83], v[48:51], v[40:43]
    s_waitcnt vmcnt(2)
    buffer_load_dwordx4 v[96:99], v2, s[16:19], s55 offen offset:3072 nt
    v_and_b32_dpp v48, v13, v32 row_newbcast:5 row_mask:0xf bank_mask:0xf
    v_and_b32_dpp v49, v13, v33 row_newbcast:5 row_mask:0xf bank_mask:0xf
    v_and_b32_dpp v50, v13, v34 row_newbcast:5 row_mask:0xf bank_mask:0xf
    v_and_b32_dpp v51, v13, v35 row_newbcast:5 row_mask:0xf bank_mask:0xf
    v_mfma_f32_16x16x32_bf16 v[40:43], v[84:87], v[44:47], v[40:43]
    s_waitcnt vmcnt(2)
    s_add_u32 s55, s55, 32768
    buffer_load_dwordx4 v[100:103], v2, s[16:19], s55 offen offset:0 nt
    v_and_b32_dpp v44, v13, v32 row_newbcast:6 row_mask:0xf bank_mask:0xf
    v_and_b32_dpp v45, v13, v33 row_newbcast:6 row_mask:0xf bank_mask:0xf
    v_and_b32_dpp v46, v13, v34 row_newbcast:6 row_mask:0xf bank_mask:0xf
    v_and_b32_dpp v47, v13, v35 row_newbcast:6 row_mask:0xf bank_mask:0xf
    v_mfma_f32_16x16x32_bf16 v[40:43], v[88:91], v[48:51], v[40:43]
    s_waitcnt vmcnt(2)
    buffer_load_dwordx4 v[104:107], v2, s[16:19], s55 offen offset:1024 nt
    v_and_b32_dpp v48, v13, v32 row_newbcast:7 row_mask:0xf bank_mask:0xf
    v_and_b32_dpp v49, v13, v33 row_newbcast:7 row_mask:0xf bank_mask:0xf
    v_and_b32_dpp v50, v13, v34 row_newbcast:7 row_mask:0xf bank_mask:0xf
    v_and_b32_dpp v51, v13, v35 row_newbcast:7 row_mask:0xf bank_mask:0xf
    v_mfma_f32_16x16x32_bf16 v[40:43], v[92:95], v[44:47], v[40:43]
    s_cmp_ge_u32 s3, 4
    s_cbranch_scc1 L_skipF_11
    s_cmp_ge_u32 s4, 28
    s_cbranch_scc1 L_skipF_11
    s_waitcnt vmcnt(0)
    s_lshl_b32 s57, s3, 3
    s_add_u32 s57, s57, 14336
    s_add_u32 s57, s57, s64
    s_mov_b64 exec, 1
    buffer_store_dwordx2 v[244:245], off, s[44:47], s57 sc0 sc1
    s_mov_b64 exec, -1
L_skipF_11:
    s_waitcnt vmcnt(2)
    buffer_load_dwordx4 v[108:111], v2, s[16:19], s55 offen offset:2048 nt
    v_and_b32_dpp v44, v13, v32 row_newbcast:8 row_mask:0xf bank_mask:0xf
    v_and_b32_dpp v45, v13, v33 row_newbcast:8 row_mask:0xf bank_mask:0xf
    v_and_b32_dpp v46, v13, v34 row_newbcast:8 row_mask:0xf bank_mask:0xf
    v_and_b32_dpp v47, v13, v35 row_newbcast:8 row_mask:0xf bank_mask:0xf
    v_mfma_f32_16x16x32_bf16 v[40:43], v[96:99], v[48:51], v[40:43]
    s_waitcnt vmcnt(2)
    buffer_load_dwordx4 v[112:115], v2, s[16:19], s55 offen offset:3072 nt
    v_and_b32_dpp v48, v13, v32 row_newbcast:9 row_mask:0xf bank_mask:0xf
    v_and_b32_dpp v49, v13, v33 row_newbcast:9 row_mask:0xf bank_mask:0xf
    v_and_b32_dpp v50, v13, v34 row_newbcast:9 row_mask:0xf bank_mask:0xf
    v_and_b32_dpp v51, v13, v35 row_newbcast:9 row_mask:0xf bank_mask:0xf
    v_mfma_f32_16x16x32_bf16 v[40:43], v[100:103], v[44:47], v[40:43]
    s_waitcnt vmcnt(2)
    s_add_u32 s55, s55, 32768
    buffer_load_dwordx4 v[116:119], v2, s[16:19], s55 offen offset:0 nt
    v_and_b32_dpp v44, v13, v32 row_newbcast:10 row_mask:0xf bank_mask:0xf
    v_and_b32_dpp v45, v13, v33 row_newbcast:10 row_mask:0xf bank_mask:0xf
    v_and_b32_dpp v46, v13, v34 row_newbcast:10 row_mask:0xf bank_mask:0xf
    v_and_b32_dpp v47, v13, v35 row_newbcast:10 row_mask:0xf bank_mask:0xf
    v_mfma_f32_16x16x32_bf16 v[40:43], v[104:107], v[48:51], v[40:43]
    s_waitcnt vmcnt(2)
    buffer_load_dwordx4 v[120:123], v2, s[16:19], s55 offen offset:1024 nt
    v_and_b32_dpp v48, v13, v32 row_newbcast:11 row_mask:0xf bank_mask:0xf
    v_and_b32_dpp v49, v13, v33 row_newbcast:11 row_mask:0xf bank_mask:0xf
    v_and_b32_dpp v50, v13, v34 row_newbcast:11 row_mask:0xf bank_mask:0xf
    v_and_b32_dpp v51, v13, v35 row_newbcast:11 row_mask:0xf bank_mask:0xf
    v_mfma_f32_16x16x32_bf16 v[40:43], v[108:111], v[44:47], v[40:43]
    s_waitcnt vmcnt(2)
    buffer_load_dwordx4 v[124:127], v2, s[16:19], s55 offen offset:2048 nt
    v_and_b32_dpp v44, v13, v32 row_newbcast:12 row_mask:0xf bank_mask:0xf
    v_and_b32_dpp v45, v13, v33 row_newbcast:12 row_mask:0xf bank_mask:0xf
    v_and_b32_dpp v46, v13, v34 row_newbcast:12 row_mask:0xf bank_mask:0xf
    v_and_b32_dpp v47, v13, v35 row_newbcast:12 row_mask:0xf bank_mask:0xf
    v_mfma_f32_16x16x32_bf16 v[40:43], v[112:115], v[48:51], v[40:43]
    s_waitcnt vmcnt(2)
    buffer_load_dwordx4 v[128:131], v2, s[16:19], s55 offen offset:3072 nt
    v_and_b32_dpp v48, v13, v32 row_newbcast:13 row_mask:0xf bank_mask:0xf
    v_and_b32_dpp v49, v13, v33 row_newbcast:13 row_mask:0xf bank_mask:0xf
    v_and_b32_dpp v50, v13, v34 row_newbcast:13 row_mask:0xf bank_mask:0xf
    v_and_b32_dpp v51, v13, v35 row_newbcast:13 row_mask:0xf bank_mask:0xf
    v_mfma_f32_16x16x32_bf16 v[40:43], v[116:119], v[44:47], v[40:43]
    s_waitcnt vmcnt(2)
    s_mov_b32 s54, s84
    buffer_load_dwordx4 v[68:71], v2, s[12:15], s54 offen offset:0 nt
    v_and_b32_dpp v44, v13, v32 row_newbcast:14 row_mask:0xf bank_mask:0xf
    v_and_b32_dpp v45, v13, v33 row_newbcast:14 row_mask:0xf bank_mask:0xf
    v_and_b32_dpp v46, v13, v34 row_newbcast:14 row_mask:0xf bank_mask:0xf
    v_and_b32_dpp v47, v13, v35 row_newbcast:14 row_mask:0xf bank_mask:0xf
    v_mfma_f32_16x16x32_bf16 v[40:43], v[120:123], v[48:51], v[40:43]
    s_waitcnt vmcnt(2)
    buffer_load_dwordx4 v[72:75], v2, s[12:15], s54 offen offset:1024 nt
    v_and_b32_dpp v48, v13, v32 row_newbcast:15 row_mask:0xf bank_mask:0xf
    v_and_b32_dpp v49, v13, v33 row_newbcast:15 row_mask:0xf bank_mask:0xf
    v_and_b32_dpp v50, v13, v34 row_newbcast:15 row_mask:0xf bank_mask:0xf
    v_and_b32_dpp v51, v13, v35 row_newbcast:15 row_mask:0xf bank_mask:0xf
    v_mfma_f32_16x16x32_bf16 v[40:43], v[124:127], v[44:47], v[40:43]
    s_waitcnt vmcnt(2)
    buffer_load_dwordx4 v[76:79], v2, s[12:15], s54 offen offset:2048 nt
    s_nop 1
    v_mfma_f32_16x16x32_bf16 v[40:43], v[128:131], v[48:51], v[40:43]
    s_setprio 0
    s_mov_b32 s56, 3
L_LOOP:
    s_mov_b32 s83, s84
    s_add_u32 s84, s83, 131072
    s_waitcnt vmcnt(2)
    buffer_load_dwordx4 v[80:83], v2, s[12:15], s54 offen offset:3072 nt
    v_dot2_f32_bf16 v52, v68, v36, 0
    v_dot2_f32_bf16 v52, v69, v37, v52
    v_dot2_f32_bf16 v52, v70, v38, v52
    v_dot2_f32_bf16 v52, v71, v39, v52
    s_waitcnt vmcnt(2)
    s_add_u32 s54, s54, 32768
    buffer_load_dwordx4 v[84:87], v2, s[12:15], s54 offen offset:0 nt
    v_dot2_f32_bf16 v53, v72, v36, 0
    v_dot2_f32_bf16 v53, v73, v37, v53
    v_dot2_f32_bf16 v53, v74, v38, v53
    v_dot2_f32_bf16 v53, v75, v39, v53
    s_waitcnt vmcnt(2)
    buffer_load_dwordx4 v[88:91], v2, s[12:15], s54 offen offset:1024 nt
    v_dot2_f32_bf16 v54, v76, v36, 0
    v_dot2_f32_bf16 v54, v77, v37, v54
    v_dot2_f32_bf16 v54, v78, v38, v54
    v_dot2_f32_bf16 v54, v79, v39, v54
    s_waitcnt vmcnt(2)
    buffer_load_dwordx4 v[92:95], v2, s[12:15], s54 offen offset:2048 nt
    v_dot2_f32_bf16 v55, v80, v36, 0
    v_dot2_f32_bf16 v55, v81, v37, v55
    v_dot2_f32_bf16 v55, v82, v38, v55
    v_dot2_f32_bf16 v55, v83, v39, v55
    s_waitcnt vmcnt(2)
    buffer_load_dwordx4 v[96:99], v2, s[12:15], s54 offen offset:3072 nt
    v_dot2_f32_bf16 v56, v84, v36, 0
    v_dot2_f32_bf16 v56, v85, v37, v56
    v_dot2_f32_bf16 v56, v86, v38, v56
    v_dot2_f32_bf16 v56, v87, v39, v56
    s_waitcnt vmcnt(2)
    s_add_u32 s54, s54, 32768
    buffer_load_dwordx4 v[100:103], v2, s[12:15], s54 offen offset:0 nt
    v_dot2_f32_bf16 v57, v88, v36, 0
    v_dot2_f32_bf16 v57, v89, v37, v57
    v_dot2_f32_bf16 v57, v90, v38, v57
    v_dot2_f32_bf16 v57, v91, v39, v57
    s_waitcnt vmcnt(2)
    buffer_load_dwordx4 v[104:107], v2, s[12:15], s54 offen offset:1024 nt
    v_dot2_f32_bf16 v58, v92, v36, 0
    v_dot2_f32_bf16 v58, v93, v37, v58
    v_dot2_f32_bf16 v58, v94, v38, v58
    v_dot2_f32_bf16 v58, v95, v39, v58
    s_waitcnt vmcnt(2)
    buffer_load_dwordx4 v[108:111], v2, s[12:15], s54 offen offset:2048 nt
    v_dot2_f32_bf16 v59, v96, v36, 0
    v_dot2_f32_bf16 v59, v97, v37, v59
    v_dot2_f32_bf16 v59, v98, v38, v59
    v_dot2_f32_bf16 v59, v99, v39, v59
    s_waitcnt vmcnt(2)
    buffer_load_dwordx4 v[112:115], v2, s[12:15], s54 offen offset:3072 nt
    v_dot2_f32_bf16 v60, v100, v36, 0
    v_dot2_f32_bf16 v60, v101, v37, v60
    v_dot2_f32_bf16 v60, v102, v38, v60
    v_dot2_f32_bf16 v60, v103, v39, v60
    s_waitcnt vmcnt(2)
    s_add_u32 s54, s54, 32768
    buffer_load_dwordx4 v[116:119], v2, s[12:15], s54 offen offset:0 nt
    v_dot2_f32_bf16 v61, v104, v36, 0
    v_dot2_f32_bf16 v61, v105, v37, v61
    v_dot2_f32_bf16 v61, v106, v38, v61
    v_dot2_f32_bf16 v61, v107, v39, v61
    s_waitcnt vmcnt(2)
    buffer_load_dwordx4 v[120:123], v2, s[12:15], s54 offen offset:1024 nt
    v_dot2_f32_bf16 v62, v108, v36, 0
    v_dot2_f32_bf16 v62, v109, v37, v62
    v_dot2_f32_bf16 v62, v110, v38, v62
    v_dot2_f32_bf16 v62, v111, v39, v62
    s_waitcnt vmcnt(2)
    buffer_load_dwordx4 v[124:127], v2, s[12:15], s54 offen offset:2048 nt
    v_dot2_f32_bf16 v63, v112, v36, 0
    v_dot2_f32_bf16 v63, v113, v37, v63
    v_dot2_f32_bf16 v63, v114, v38, v63
    v_dot2_f32_bf16 v63, v115, v39, v63
    s_waitcnt vmcnt(2)
    buffer_load_dwordx4 v[128:131], v2, s[12:15], s54 offen offset:3072 nt
    v_dot2_f32_bf16 v64, v116, v36, 0
    v_dot2_f32_bf16 v64, v117, v37, v64
    v_dot2_f32_bf16 v64, v118, v38, v64
    v_dot2_f32_bf16 v64, v119, v39, v64
    s_waitcnt vmcnt(2)
    s_mov_b32 s55, s83
    buffer_load_dwordx4 v[68:71], v2, s[16:19], s55 offen offset:0 nt
    v_dot2_f32_bf16 v65, v120, v36, 0
    v_dot2_f32_bf16 v65, v121, v37, v65
    v_dot2_f32_bf16 v65, v122, v38, v65
    v_dot2_f32_bf16 v65, v123, v39, v65
    s_waitcnt vmcnt(2)
    buffer_load_dwordx4 v[72:75], v2, s[16:19], s55 offen offset:1024 nt
    v_dot2_f32_bf16 v66, v124, v36, 0
    v_dot2_f32_bf16 v66, v125, v37, v66
    v_dot2_f32_bf16 v66, v126, v38, v66
    v_dot2_f32_bf16 v66, v127, v39, v66
    s_waitcnt vmcnt(2)
    buffer_load_dwordx4 v[76:79], v2, s[16:19], s55 offen offset:2048 nt
    v_dot2_f32_bf16 v67, v128, v36, 0
    v_dot2_f32_bf16 v67, v129, v37, v67
    v_dot2_f32_bf16 v67, v130, v38, v67
    v_dot2_f32_bf16 v67, v131, v39, v67
    s_nop 2
    v_add_f32_dpp v52, v52, v52 row_ror:8 row_mask:0xf bank_mask:0x3
    v_add_f32_dpp v53, v53, v53 row_ror:8 row_mask:0xf bank_mask:0x3
    v_add_f32_dpp v54, v54, v54 row_ror:8 row_mask:0xf bank_mask:0x3
    v_add_f32_dpp v55, v55, v55 row_ror:8 row_mask:0xf bank_mask:0x3
    v_add_f32_dpp v56, v56, v56 row_ror:8 row_mask:0xf bank_mask:0x3
    v_add_f32_dpp v57, v57, v57 row_ror:8 row_mask:0xf bank_mask:0x3
    v_add_f32_dpp v58, v58, v58 row_ror:8 row_mask:0xf bank_mask:0x3
    v_add_f32_dpp v59, v59, v59 row_ror:8 row_mask:0xf bank_mask:0x3
    v_add_f32_dpp v52, v60, v60 row_ror:8 row_mask:0xf bank_mask:0xc
    v_add_f32_dpp v53, v61, v61 row_ror:8 row_mask:0xf bank_mask:0xc
    v_add_f32_dpp v54, v62, v62 row_ror:8 row_mask:0xf bank_mask:0xc
    v_add_f32_dpp v55, v63, v63 row_ror:8 row_mask:0xf bank_mask:0xc
    v_add_f32_dpp v56, v64, v64 row_ror:8 row_mask:0xf bank_mask:0xc
    v_add_f32_dpp v57, v65, v65 row_ror:8 row_mask:0xf bank_mask:0xc
    v_add_f32_dpp v58, v66, v66 row_ror:8 row_mask:0xf bank_mask:0xc
    v_add_f32_dpp v59, v67, v67 row_ror:8 row_mask:0xf bank_mask:0xc
    v_add_f32_dpp v52, v52, v52 row_ror:12 row_mask:0xf bank_mask:0x5
    v_add_f32_dpp v53, v53, v53 row_ror:12 row_mask:0xf bank_mask:0x5
    v_add_f32_dpp v54, v54, v54 row_ror:12 row_mask:0xf bank_mask:0x5
    v_add_f32_dpp v55, v55, v55 row_ror:12 row_mask:0xf bank_mask:0x5
    v_add_f32_dpp v52, v56, v56 row_ror:4 row_mask:0xf bank_mask:0xa
    v_add_f32_dpp v53, v57, v57 row_ror:4 row_mask:0xf bank_mask:0xa
    v_add_f32_dpp v54, v58, v58 row_ror:4 row_mask:0xf bank_mask:0xa
    v_add_f32_dpp v55, v59, v59 row_ror:4 row_mask:0xf bank_mask:0xa
    v_add_f32_dpp v60, v52, v52 quad_perm:[2,3,0,1] row_mask:0xf bank_mask:0xf
    v_add_f32_dpp v61, v53, v53 quad_perm:[2,3,0,1] row_mask:0xf bank_mask:0xf
    v_add_f32_dpp v62, v54, v54 quad_perm:[2,3,0,1] row_mask:0xf bank_mask:0xf
    v_add_f32_dpp v63, v55, v55 quad_perm:[2,3,0,1] row_mask:0xf bank_mask:0xf
    v_cndmask_b32_e64 v52, v60, v62, s[96:97]
    v_cndmask_b32_e64 v53, v61, v63, s[96:97]
    s_nop 0
    v_add_f32_dpp v60, v52, v52 quad_perm:[1,0,3,2] row_mask:0xf bank_mask:0xf
    v_add_f32_dpp v61, v53, v53 quad_perm:[1,0,3,2] row_mask:0xf bank_mask:0xf
    v_cndmask_b32_e64 v14, v60, v61, s[94:95]
    v_cvt_pk_bf16_f32 v14, v14, v14
    v_and_b32 v14, 0xffff0000, v14
    v_mul_f32 v14, 0x3db504f3, v14
    v_cvt_pk_bf16_f32 v14, v14, v14
    v_and_b32 v14, 0xffff0000, v14
    v_mov_b32 v15, v14
    s_nop 1
    v_max_f32_dpp v15, v15, v15 row_ror:8 row_mask:0xf bank_mask:0xf
    s_nop 1
    v_max_f32_dpp v15, v15, v15 row_ror:4 row_mask:0xf bank_mask:0xf
    s_nop 1
    v_max_f32_dpp v15, v15, v15 row_ror:2 row_mask:0xf bank_mask:0xf
    s_nop 1
    v_max_f32_dpp v15, v15, v15 row_ror:1 row_mask:0xf bank_mask:0xf
    v_mov_b32 v16, v15
    s_nop 1
    v_permlane16_swap_b32 v15, v16
    s_nop 0
    v_max_f32 v15, v15, v16
    v_mov_b32 v16, v15
    s_nop 1
    v_permlane32_swap_b32 v15, v16
    s_nop 0
    v_max_f32 v15, v15, v16
    v_max_f32 v15, v15, v11
    v_sub_f32 v16, v11, v15
    v_sub_f32 v14, v14, v15
    v_mul_f32 v16, 0x3fb8aa3b, v16
    v_mul_f32 v14, 0x3fb8aa3b, v14
    v_exp_f32 v16, v16
    v_exp_f32 v14, v14
    v_mov_b32 v11, v15
    v_cvt_pk_bf16_f32 v13, v14, v14
    v_fma_f32 v12, v12, v16, v14
    v_mul_f32 v40, v16, v40
    v_mul_f32 v41, v16, v41
    v_mul_f32 v42, v16, v42
    v_mul_f32 v43, v16, v43
    v_and_b32_dpp v44, v13, v32 row_newbcast:0 row_mask:0xf bank_mask:0xf
    v_and_b32_dpp v45, v13, v33 row_newbcast:0 row_mask:0xf bank_mask:0xf
    v_and_b32_dpp v46, v13, v34 row_newbcast:0 row_mask:0xf bank_mask:0xf
    v_and_b32_dpp v47, v13, v35 row_newbcast:0 row_mask:0xf bank_mask:0xf
    s_waitcnt vmcnt(2)
    buffer_load_dwordx4 v[80:83], v2, s[16:19], s55 offen offset:3072 nt
    v_and_b32_dpp v48, v13, v32 row_newbcast:1 row_mask:0xf bank_mask:0xf
    v_and_b32_dpp v49, v13, v33 row_newbcast:1 row_mask:0xf bank_mask:0xf
    v_and_b32_dpp v50, v13, v34 row_newbcast:1 row_mask:0xf bank_mask:0xf
    v_and_b32_dpp v51, v13, v35 row_newbcast:1 row_mask:0xf bank_mask:0xf
    v_mfma_f32_16x16x32_bf16 v[40:43], v[68:71], v[44:47], v[40:43]
    s_waitcnt vmcnt(2)
    s_add_u32 s55, s55, 32768
    buffer_load_dwordx4 v[84:87], v2, s[16:19], s55 offen offset:0 nt
    v_and_b32_dpp v44, v13, v32 row_newbcast:2 row_mask:0xf bank_mask:0xf
    v_and_b32_dpp v45, v13, v33 row_newbcast:2 row_mask:0xf bank_mask:0xf
    v_and_b32_dpp v46, v13, v34 row_newbcast:2 row_mask:0xf bank_mask:0xf
    v_and_b32_dpp v47, v13, v35 row_newbcast:2 row_mask:0xf bank_mask:0xf
    v_mfma_f32_16x16x32_bf16 v[40:43], v[72:75], v[48:51], v[40:43]
    s_waitcnt vmcnt(2)
    buffer_load_dwordx4 v[88:91], v2, s[16:19], s55 offen offset:1024 nt
    v_and_b32_dpp v48, v13, v32 row_newbcast:3 row_mask:0xf bank_mask:0xf
    v_and_b32_dpp v49, v13, v33 row_newbcast:3 row_mask:0xf bank_mask:0xf
    v_and_b32_dpp v50, v13, v34 row_newbcast:3 row_mask:0xf bank_mask:0xf
    v_and_b32_dpp v51, v13, v35 row_newbcast:3 row_mask:0xf bank_mask:0xf
    v_mfma_f32_16x16x32_bf16 v[40:43], v[76:79], v[44:47], v[40:43]
    s_waitcnt vmcnt(2)
    buffer_load_dwordx4 v[92:95], v2, s[16:19], s55 offen offset:2048 nt
    v_and_b32_dpp v44, v13, v32 row_newbcast:4 row_mask:0xf bank_mask:0xf
    v_and_b32_dpp v45, v13, v33 row_newbcast:4 row_mask:0xf bank_mask:0xf
    v_and_b32_dpp v46, v13, v34 row_newbcast:4 row_mask:0xf bank_mask:0xf
    v_and_b32_dpp v47, v13, v35 row_newbcast:4 row_mask:0xf bank_mask:0xf
    v_mfma_f32_16x16x32_bf16 v[40:43], v[80:83], v[48:51], v[40:43]
    s_waitcnt vmcnt(2)
    buffer_load_dwordx4 v[96:99], v2, s[16:19], s55 offen offset:3072 nt
    v_and_b32_dpp v48, v13, v32 row_newbcast:5 row_mask:0xf bank_mask:0xf
    v_and_b32_dpp v49, v13, v33 row_newbcast:5 row_mask:0xf bank_mask:0xf
    v_and_b32_dpp v50, v13, v34 row_newbcast:5 row_mask:0xf bank_mask:0xf
    v_and_b32_dpp v51, v13, v35 row_newbcast:5 row_mask:0xf bank_mask:0xf
    v_mfma_f32_16x16x32_bf16 v[40:43], v[84:87], v[44:47], v[40:43]
    s_waitcnt vmcnt(2)
    s_add_u32 s55, s55, 32768
    buffer_load_dwordx4 v[100:103], v2, s[16:19], s55 offen offset:0 nt
    v_and_b32_dpp v44, v13, v32 row_newbcast:6 row_mask:0xf bank_mask:0xf
    v_and_b32_dpp v45, v13, v33 row_newbcast:6 row_mask:0xf bank_mask:0xf
    v_and_b32_dpp v46, v13, v34 row_newbcast:6 row_mask:0xf bank_mask:0xf
    v_and_b32_dpp v47, v13, v35 row_newbcast:6 row_mask:0xf bank_mask:0xf
    v_mfma_f32_16x16x32_bf16 v[40:43], v[88:91], v[48:51], v[40:43]
    s_waitcnt vmcnt(2)
    buffer_load_dwordx4 v[104:107], v2, s[16:19], s55 offen offset:1024 nt
    v_and_b32_dpp v48, v13, v32 row_newbcast:7 row_mask:0xf bank_mask:0xf
    v_and_b32_dpp v49, v13, v33 row_newbcast:7 row_mask:0xf bank_mask:0xf
    v_and_b32_dpp v50, v13, v34 row_newbcast:7 row_mask:0xf bank_mask:0xf
    v_and_b32_dpp v51, v13, v35 row_newbcast:7 row_mask:0xf bank_mask:0xf
    v_mfma_f32_16x16x32_bf16 v[40:43], v[92:95], v[44:47], v[40:43]
    s_waitcnt vmcnt(2)
    buffer_load_dwordx4 v[108:111], v2, s[16:19], s55 offen offset:2048 nt
    v_and_b32_dpp v44, v13, v32 row_newbcast:8 row_mask:0xf bank_mask:0xf
    v_and_b32_dpp v45, v13, v33 row_newbcast:8 row_mask:0xf bank_mask:0xf
    v_and_b32_dpp v46, v13, v34 row_newbcast:8 row_mask:0xf bank_mask:0xf
    v_and_b32_dpp v47, v13, v35 row_newbcast:8 row_mask:0xf bank_mask:0xf
    v_mfma_f32_16x16x32_bf16 v[40:43], v[96:99], v[48:51], v[40:43]
    s_waitcnt vmcnt(2)
    buffer_load_dwordx4 v[112:115], v2, s[16:19], s55 offen offset:3072 nt
    v_and_b32_dpp v48, v13, v32 row_newbcast:9 row_mask:0xf bank_mask:0xf
    v_and_b32_dpp v49, v13, v33 row_newbcast:9 row_mask:0xf bank_mask:0xf
    v_and_b32_dpp v50, v13, v34 row_newbcast:9 row_mask:0xf bank_mask:0xf
    v_and_b32_dpp v51, v13, v35 row_newbcast:9 row_mask:0xf bank_mask:0xf
    v_mfma_f32_16x16x32_bf16 v[40:43], v[100:103], v[44:47], v[40:43]
    s_waitcnt vmcnt(2)
    s_add_u32 s55, s55, 32768
    buffer_load_dwordx4 v[116:119], v2, s[16:19], s55 offen offset:0 nt
    v_and_b32_dpp v44, v13, v32 row_newbcast:10 row_mask:0xf bank_mask:0xf
    v_and_b32_dpp v45, v13, v33 row_newbcast:10 row_mask:0xf bank_mask:0xf
    v_and_b32_dpp v46, v13, v34 row_newbcast:10 row_mask:0xf bank_mask:0xf
    v_and_b32_dpp v47, v13, v35 row_newbcast:10 row_mask:0xf bank_mask:0xf
    v_mfma_f32_16x16x32_bf16 v[40:43], v[104:107], v[48:51], v[40:43]
    s_waitcnt vmcnt(2)
    buffer_load_dwordx4 v[120:123], v2, s[16:19], s55 offen offset:1024 nt
    v_and_b32_dpp v48, v13, v32 row_newbcast:11 row_mask:0xf bank_mask:0xf
    v_and_b32_dpp v49, v13, v33 row_newbcast:11 row_mask:0xf bank_mask:0xf
    v_and_b32_dpp v50, v13, v34 row_newbcast:11 row_mask:0xf bank_mask:0xf
    v_and_b32_dpp v51, v13, v35 row_newbcast:11 row_mask:0xf bank_mask:0xf
    v_mfma_f32_16x16x32_bf16 v[40:43], v[108:111], v[44:47], v[40:43]
    s_waitcnt vmcnt(2)
    buffer_load_dwordx4 v[124:127], v2, s[16:19], s55 offen offset:2048 nt
    v_and_b32_dpp v44, v13, v32 row_newbcast:12 row_mask:0xf bank_mask:0xf
    v_and_b32_dpp v45, v13, v33 row_newbcast:12 row_mask:0xf bank_mask:0xf
    v_and_b32_dpp v46, v13, v34 row_newbcast:12 row_mask:0xf bank_mask:0xf
    v_and_b32_dpp v47, v13, v35 row_newbcast:12 row_mask:0xf bank_mask:0xf
    v_mfma_f32_16x16x32_bf16 v[40:43], v[112:115], v[48:51], v[40:43]
    s_waitcnt vmcnt(2)
    buffer_load_dwordx4 v[128:131], v2, s[16:19], s55 offen offset:3072 nt
    v_and_b32_dpp v48, v13, v32 row_newbcast:13 row_mask:0xf bank_mask:0xf
    v_and_b32_dpp v49, v13, v33 row_newbcast:13 row_mask:0xf bank_mask:0xf
    v_and_b32_dpp v50, v13, v34 row_newbcast:13 row_mask:0xf bank_mask:0xf
    v_and_b32_dpp v51, v13, v35 row_newbcast:13 row_mask:0xf bank_mask:0xf
    v_mfma_f32_16x16x32_bf16 v[40:43], v[116:119], v[44:47], v[40:43]
    s_waitcnt vmcnt(2)
    s_mov_b32 s54, s84
    buffer_load_dwordx4 v[68:71], v2, s[12:15], s54 offen offset:0 nt
    v_and_b32_dpp v44, v13, v32 row_newbcast:14 row_mask:0xf bank_mask:0xf
    v_and_b32_dpp v45, v13, v33 row_newbcast:14 row_mask:0xf bank_mask:0xf
    v_and_b32_dpp v46, v13, v34 row_newbcast:14 row_mask:0xf bank_mask:0xf
    v_and_b32_dpp v47, v13, v35 row_newbcast:14 row_mask:0xf bank_mask:0xf
    v_mfma_f32_16x16x32_bf16 v[40:43], v[120:123], v[48:51], v[40:43]
    s_waitcnt vmcnt(2)
    buffer_load_dwordx4 v[72:75], v2, s[12:15], s54 offen offset:1024 nt
    v_and_b32_dpp v48, v13, v32 row_newbcast:15 row_mask:0xf bank_mask:0xf
    v_and_b32_dpp v49, v13, v33 row_newbcast:15 row_mask:0xf bank_mask:0xf
    v_and_b32_dpp v50, v13, v34 row_newbcast:15 row_mask:0xf bank_mask:0xf
    v_and_b32_dpp v51, v13, v35 row_newbcast:15 row_mask:0xf bank_mask:0xf
    v_mfma_f32_16x16x32_bf16 v[40:43], v[124:127], v[44:47], v[40:43]
    s_waitcnt vmcnt(2)
    buffer_load_dwordx4 v[76:79], v2, s[12:15], s54 offen offset:2048 nt
    s_nop 1
    v_mfma_f32_16x16x32_bf16 v[40:43], v[128:131], v[48:51], v[40:43]
    s_sub_u32 s56, s56, 1
    s_cmp_lg_u32 s56, 0
    s_cbranch_scc1 L_LOOP
    s_mov_b32 s83, s84
    s_add_u32 s84, s83, 131072
    s_waitcnt vmcnt(2)
    buffer_load_dwordx4 v[80:83], v2, s[12:15], s54 offen offset:3072 nt
    v_dot2_f32_bf16 v52, v68, v36, 0
    v_dot2_f32_bf16 v52, v69, v37, v52
    v_dot2_f32_bf16 v52, v70, v38, v52
    v_dot2_f32_bf16 v52, v71, v39, v52
    s_and_b32 s57, s4, 7
    s_cmp_eq_u32 s57, s5
    s_cselect_b32 s89, 1, 0
    s_cmp_ge_u32 s3, 4
    s_cselect_b32 s89, s89, 0
    s_cmp_lt_u32 s4, 28
    s_cselect_b32 s89, s89, 0
    s_cmp_eq_u32 s89, 0
    s_cbranch_scc1 L_h1s_12
    s_bfe_u32 s61, s3, 0x10001
    v_bfe_u32 v233, v1, 1, 3
    s_mov_b32 s57, 16896
    v_mul_lo_u32 v233, v233, s57
    v_and_b32 v234, 1, v1
    v_lshlrev_b32 v234, 4, v234
    v_add_u32 v233, v233, v234
    s_lshl_b32 s57, s61, 3
    s_add_u32 s57, s57, 14336
    v_add_u32 v233, s57, v233
    buffer_load_dwordx2 v[234:235], v233, s[44:47], s65 offen sc1
L_h1s_12:
    s_waitcnt vmcnt(2)
    s_add_u32 s54, s54, 32768
    buffer_load_dwordx4 v[84:87], v2, s[12:15], s54 offen offset:0 nt
    v_dot2_f32_bf16 v53, v72, v36, 0
    v_dot2_f32_bf16 v53, v73, v37, v53
    v_dot2_f32_bf16 v53, v74, v38, v53
    v_dot2_f32_bf16 v53, v75, v39, v53
    s_waitcnt vmcnt(2)
    buffer_load_dwordx4 v[88:91], v2, s[12:15], s54 offen offset:1024 nt
    v_dot2_f32_bf16 v54, v76, v36, 0
    v_dot2_f32_bf16 v54, v77, v37, v54
    v_dot2_f32_bf16 v54, v78, v38, v54
    v_dot2_f32_bf16 v54, v79, v39, v54
    s_waitcnt vmcnt(2)
    buffer_load_dwordx4 v[92:95], v2, s[12:15], s54 offen offset:2048 nt
    v_dot2_f32_bf16 v55, v80, v36, 0
    v_dot2_f32_bf16 v55, v81, v37, v55
    v_dot2_f32_bf16 v55, v82, v38, v55
    v_dot2_f32_bf16 v55, v83, v39, v55
    s_waitcnt vmcnt(2)
    buffer_load_dwordx4 v[96:99], v2, s[12:15], s54 offen offset:3072 nt
    v_dot2_f32_bf16 v56, v84, v36, 0
    v_dot2_f32_bf16 v56, v85, v37, v56
    v_dot2_f32_bf16 v56, v86, v38, v56
    v_dot2_f32_bf16 v56, v87, v39, v56
    s_cmp_eq_u32 s89, 0
    s_cbranch_scc1 L_h1s_13
    s_mov_b32 s66, 200000
L_bf_14:
    v_cmp_eq_u64 vcc, v[234:235], v[244:245]
    s_nop 0
    s_cmp_eq_u64 vcc, -1
    s_cbranch_scc1 L_bfok_15
    buffer_load_dwordx2 v[234:235], v233, s[44:47], s65 offen sc1
    s_waitcnt vmcnt(0)
    s_sub_u32 s66, s66, 1
    s_cbranch_scc0 L_bf_14
L_bfok_15:
    s_bfe_u32 s61, s3, 0x10001
    s_and_b32 s58, s3, 1
    s_lshl_b32 s57, s61, 9
    s_lshl_b32 s59, s58, 8
    s_add_u32 s57, s57, s59
    s_add_u32 s57, s57, 2048
    v_and_b32 v233, 31, v1
    v_lshlrev_b32 v233, 3, v233
    v_lshrrev_b32 v234, 5, v1
    v_lshlrev_b32 v234, 10, v234
    v_add_u32 v233, v233, v234
    v_add_u32 v233, s57, v233
L_h1s_13:
    s_waitcnt vmcnt(2)
    s_add_u32 s54, s54, 32768
    buffer_load_dwordx4 v[100:103], v2, s[12:15], s54 offen offset:0 nt
    v_dot2_f32_bf16 v57, v88, v36, 0
    v_dot2_f32_bf16 v57, v89, v37, v57
    v_dot2_f32_bf16 v57, v90, v38, v57
    v_dot2_f32_bf16 v57, v91, v39, v57
    s_cmp_eq_u32 s89, 0
    s_cbranch_scc1 L_h1s_16
    s_add_u32 s63, s65, 0
    buffer_load_dwordx2 v[180:181], v233, s[44:47], s63 offen sc1 nt
L_h1s_16:
    s_waitcnt vmcnt(2)
    buffer_load_dwordx4 v[104:107], v2, s[12:15], s54 offen offset:1024 nt
    v_dot2_f32_bf16 v58, v92, v36, 0
    v_dot2_f32_bf16 v58, v93, v37, v58
    v_dot2_f32_bf16 v58, v94, v38, v58
    v_dot2_f32_bf16 v58, v95, v39, v58
    s_cmp_eq_u32 s89, 0
    s_cbranch_scc1 L_h1s_17
    s_add_u32 s63, s65, 16896
    buffer_load_dwordx2 v[182:183], v233, s[44:47], s63 offen sc1 nt
L_h1s_17:
    s_waitcnt vmcnt(2)
    buffer_load_dwordx4 v[108:111], v2, s[12:15], s54 offen offset:2048 nt
    v_dot2_f32_bf16 v59, v96, v36, 0
    v_dot2_f32_bf16 v59, v97, v37, v59
    v_dot2_f32_bf16 v59, v98, v38, v59
    v_dot2_f32_bf16 v59, v99, v39, v59
    s_cmp_eq_u32 s89, 0
    s_cbranch_scc1 L_h1s_18
    s_add_u32 s63, s65, 33792
    buffer_load_dwordx2 v[184:185], v233, s[44:47], s63 offen sc1 nt
L_h1s_18:
    s_waitcnt vmcnt(2)
    buffer_load_dwordx4 v[112:115], v2, s[12:15], s54 offen offset:3072 nt
    v_dot2_f32_bf16 v60, v100, v36, 0
    v_dot2_f32_bf16 v60, v101, v37, v60
    v_dot2_f32_bf16 v60, v102, v38, v60
    v_dot2_f32_bf16 v60, v103, v39, v60
    s_cmp_eq_u32 s89, 0
    s_cbranch_scc1 L_h1s_19
    s_add_u32 s63, s65, 50688
    buffer_load_dwordx2 v[186:187], v233, s[44:47], s63 offen sc1 nt
L_h1s_19:
    s_waitcnt vmcnt(2)
    s_add_u32 s54, s54, 32768
    buffer_load_dwordx4 v[116:119], v2, s[12:15], s54 offen offset:0 nt
    v_dot2_f32_bf16 v61, v104, v36, 0
    v_dot2_f32_bf16 v61, v105, v37, v61
    v_dot2_f32_bf16 v61, v106, v38, v61
    v_dot2_f32_bf16 v61, v107, v39, v61
    s_cmp_eq_u32 s89, 0
    s_cbranch_scc1 L_h1s_20
    s_add_u32 s63, s65, 67584
    buffer_load_dwordx2 v[188:189], v233, s[44:47], s63 offen sc1 nt
L_h1s_20:
    s_waitcnt vmcnt(2)
    buffer_load_dwordx4 v[120:123], v2, s[12:15], s54 offen offset:1024 nt
    v_dot2_f32_bf16 v62, v108, v36, 0
    v_dot2_f32_bf16 v62, v109, v37, v62
    v_dot2_f32_bf16 v62, v110, v38, v62
    v_dot2_f32_bf16 v62, v111, v39, v62
    s_cmp_eq_u32 s89, 0
    s_cbranch_scc1 L_h1s_21
    s_add_u32 s63, s65, 84480
    buffer_load_dwordx2 v[190:191], v233, s[44:47], s63 offen sc1 nt
L_h1s_21:
    s_waitcnt vmcnt(2)
    buffer_load_dwordx4 v[124:127], v2, s[12:15], s54 offen offset:2048 nt
    v_dot2_f32_bf16 v63, v112, v36, 0
    v_dot2_f32_bf16 v63, v113, v37, v63
    v_dot2_f32_bf16 v63, v114, v38, v63
    v_dot2_f32_bf16 v63, v115, v39, v63
    s_cmp_eq_u32 s89, 0
    s_cbranch_scc1 L_h1s_22
    s_add_u32 s63, s65, 101376
    buffer_load_dwordx2 v[192:193], v233, s[44:47], s63 offen sc1 nt
L_h1s_22:
    s_waitcnt vmcnt(2)
    buffer_load_dwordx4 v[128:131], v2, s[12:15], s54 offen offset:3072 nt
    v_dot2_f32_bf16 v64, v116, v36, 0
    v_dot2_f32_bf16 v64, v117, v37, v64
    v_dot2_f32_bf16 v64, v118, v38, v64
    v_dot2_f32_bf16 v64, v119, v39, v64
    s_cmp_eq_u32 s89, 0
    s_cbranch_scc1 L_h1s_23
    s_add_u32 s63, s65, 118272
    buffer_load_dwordx2 v[194:195], v233, s[44:47], s63 offen sc1 nt
L_h1s_23:
    s_waitcnt vmcnt(2)
    s_mov_b32 s55, s83
    buffer_load_dwordx4 v[68:71], v2, s[16:19], s55 offen offset:0 nt
    v_dot2_f32_bf16 v65, v120, v36, 0
    v_dot2_f32_bf16 v65, v121, v37, v65
    v_dot2_f32_bf16 v65, v122, v38, v65
    v_dot2_f32_bf16 v65, v123, v39, v65
    s_waitcnt vmcnt(2)
    buffer_load_dwordx4 v[72:75], v2, s[16:19], s55 offen offset:1024 nt
    v_dot2_f32_bf16 v66, v124, v36, 0
    v_dot2_f32_bf16 v66, v125, v37, v66
    v_dot2_f32_bf16 v66, v126, v38, v66
    v_dot2_f32_bf16 v66, v127, v39, v66
    s_waitcnt vmcnt(2)
    buffer_load_dwordx4 v[76:79], v2, s[16:19], s55 offen offset:2048 nt
    v_dot2_f32_bf16 v67, v128, v36, 0
    v_dot2_f32_bf16 v67, v129, v37, v67
    v_dot2_f32_bf16 v67, v130, v38, v67
    v_dot2_f32_bf16 v67, v131, v39, v67
    s_nop 2
    v_add_f32_dpp v52, v52, v52 row_ror:8 row_mask:0xf bank_mask:0x3
    v_add_f32_dpp v53, v53, v53 row_ror:8 row_mask:0xf bank_mask:0x3
    v_add_f32_dpp v54, v54, v54 row_ror:8 row_mask:0xf bank_mask:0x3
    v_add_f32_dpp v55, v55, v55 row_ror:8 row_mask:0xf bank_mask:0x3
    v_add_f32_dpp v56, v56, v56 row_ror:8 row_mask:0xf bank_mask:0x3
    v_add_f32_dpp v57, v57, v57 row_ror:8 row_mask:0xf bank_mask:0x3
    v_add_f32_dpp v58, v58, v58 row_ror:8 row_mask:0xf bank_mask:0x3
    v_add_f32_dpp v59, v59, v59 row_ror:8 row_mask:0xf bank_mask:0x3
    v_add_f32_dpp v52, v60, v60 row_ror:8 row_mask:0xf bank_mask:0xc
    v_add_f32_dpp v53, v61, v61 row_ror:8 row_mask:0xf bank_mask:0xc
    v_add_f32_dpp v54, v62, v62 row_ror:8 row_mask:0xf bank_mask:0xc
    v_add_f32_dpp v55, v63, v63 row_ror:8 row_mask:0xf bank_mask:0xc
    v_add_f32_dpp v56, v64, v64 row_ror:8 row_mask:0xf bank_mask:0xc
    v_add_f32_dpp v57, v65, v65 row_ror:8 row_mask:0xf bank_mask:0xc
    v_add_f32_dpp v58, v66, v66 row_ror:8 row_mask:0xf bank_mask:0xc
    v_add_f32_dpp v59, v67, v67 row_ror:8 row_mask:0xf bank_mask:0xc
    v_add_f32_dpp v52, v52, v52 row_ror:12 row_mask:0xf bank_mask:0x5
    v_add_f32_dpp v53, v53, v53 row_ror:12 row_mask:0xf bank_mask:0x5
    v_add_f32_dpp v54, v54, v54 row_ror:12 row_mask:0xf bank_mask:0x5
    v_add_f32_dpp v55, v55, v55 row_ror:12 row_mask:0xf bank_mask:0x5
    v_add_f32_dpp v52, v56, v56 row_ror:4 row_mask:0xf bank_mask:0xa
    v_add_f32_dpp v53, v57, v57 row_ror:4 row_mask:0xf bank_mask:0xa
    v_add_f32_dpp v54, v58, v58 row_ror:4 row_mask:0xf bank_mask:0xa
    v_add_f32_dpp v55, v59, v59 row_ror:4 row_mask:0xf bank_mask:0xa
    v_add_f32_dpp v60, v52, v52 quad_perm:[2,3,0,1] row_mask:0xf bank_mask:0xf
    v_add_f32_dpp v61, v53, v53 quad_perm:[2,3,0,1] row_mask:0xf bank_mask:0xf
    v_add_f32_dpp v62, v54, v54 quad_perm:[2,3,0,1] row_mask:0xf bank_mask:0xf
    v_add_f32_dpp v63, v55, v55 quad_perm:[2,3,0,1] row_mask:0xf bank_mask:0xf
    v_cndmask_b32_e64 v52, v60, v62, s[96:97]
    v_cndmask_b32_e64 v53, v61, v63, s[96:97]
    s_nop 0
    v_add_f32_dpp v60, v52, v52 quad_perm:[1,0,3,2] row_mask:0xf bank_mask:0xf
    v_add_f32_dpp v61, v53, v53 quad_perm:[1,0,3,2] row_mask:0xf bank_mask:0xf
    v_cndmask_b32_e64 v14, v60, v61, s[94:95]
    v_cvt_pk_bf16_f32 v14, v14, v14
    v_and_b32 v14, 0xffff0000, v14
    v_mul_f32 v14, 0x3db504f3, v14
    v_cvt_pk_bf16_f32 v14, v14, v14
    v_and_b32 v14, 0xffff0000, v14
    v_mov_b32 v15, v14
    s_nop 1
    v_max_f32_dpp v15, v15, v15 row_ror:8 row_mask:0xf bank_mask:0xf
    s_nop 1
    v_max_f32_dpp v15, v15, v15 row_ror:4 row_mask:0xf bank_mask:0xf
    s_nop 1
    v_max_f32_dpp v15, v15, v15 row_ror:2 row_mask:0xf bank_mask:0xf
    s_nop 1
    v_max_f32_dpp v15, v15, v15 row_ror:1 row_mask:0xf bank_mask:0xf
    v_mov_b32 v16, v15
    s_nop 1
    v_permlane16_swap_b32 v15, v16
    s_nop 0
    v_max_f32 v15, v15, v16
    v_mov_b32 v16, v15
    s_nop 1
    v_permlane32_swap_b32 v15, v16
    s_nop 0
    v_max_f32 v15, v15, v16
    v_max_f32 v15, v15, v11
    v_sub_f32 v16, v11, v15
    v_sub_f32 v14, v14, v15
    v_mul_f32 v16, 0x3fb8aa3b, v16
    v_mul_f32 v14, 0x3fb8aa3b, v14
    v_exp_f32 v16, v16
    v_exp_f32 v14, v14
    v_mov_b32 v11, v15
    v_cvt_pk_bf16_f32 v13, v14, v14
    v_fma_f32 v12, v12, v16, v14
    v_mul_f32 v40, v16, v40
    v_mul_f32 v41, v16, v41
    v_mul_f32 v42, v16, v42
    v_mul_f32 v43, v16, v43
    v_and_b32_dpp v44, v13, v32 row_newbcast:0 row_mask:0xf bank_mask:0xf
    v_and_b32_dpp v45, v13, v33 row_newbcast:0 row_mask:0xf bank_mask:0xf
    v_and_b32_dpp v46, v13, v34 row_newbcast:0 row_mask:0xf bank_mask:0xf
    v_and_b32_dpp v47, v13, v35 row_newbcast:0 row_mask:0xf bank_mask:0xf
    s_waitcnt vmcnt(2)
    buffer_load_dwordx4 v[80:83], v2, s[16:19], s55 offen offset:3072 nt
    v_and_b32_dpp v48, v13, v32 row_newbcast:1 row_mask:0xf bank_mask:0xf
    v_and_b32_dpp v49, v13, v33 row_newbcast:1 row_mask:0xf bank_mask:0xf
    v_and_b32_dpp v50, v13, v34 row_newbcast:1 row_mask:0xf bank_mask:0xf
    v_and_b32_dpp v51, v13, v35 row_newbcast:1 row_mask:0xf bank_mask:0xf
    v_mfma_f32_16x16x32_bf16 v[40:43], v[68:71], v[44:47], v[40:43]
    s_waitcnt vmcnt(2)
    s_add_u32 s55, s55, 32768
    buffer_load_dwordx4 v[84:87], v2, s[16:19], s55 offen offset:0 nt
    v_and_b32_dpp v44, v13, v32 row_newbcast:2 row_mask:0xf bank_mask:0xf
    v_and_b32_dpp v45, v13, v33 row_newbcast:2 row_mask:0xf bank_mask:0xf
    v_and_b32_dpp v46, v13, v34 row_newbcast:2 row_mask:0xf bank_mask:0xf
    v_and_b32_dpp v47, v13, v35 row_newbcast:2 row_mask:0xf bank_mask:0xf
    v_mfma_f32_16x16x32_bf16 v[40:43], v[72:75], v[48:51], v[40:43]
    s_cmp_eq_u32 s89, 0
    s_cbranch_scc1 L_h1s_24
    s_bfe_u32 s61, s3, 0x10001
    s_and_b32 s58, s3, 1
    s_lshl_b32 s57, s61, 10
    s_lshl_b32 s59, s58, 9
    s_add_u32 s57, s57, s59
    s_add_u32 s57, s57, 12288
    v_and_b32 v214, 31, v1
    v_lshlrev_b32 v214, 4, v214
    v_add_u32 v214, s57, v214
    v_add_f32 v180, v180, v182
    v_add_f32 v184, v184, v186
    v_add_f32 v188, v188, v190
    v_add_f32 v192, v192, v194
    v_add_f32 v180, v180, v184
    v_add_f32 v188, v188, v192
    v_add_f32 v220, v180, v188
    v_add_f32 v181, v181, v183
    v_add_f32 v185, v185, v187
    v_add_f32 v189, v189, v191
    v_add_f32 v193, v193, v195
    v_add_f32 v181, v181, v185
    v_add_f32 v189, v189, v193
    v_add_f32 v221, v181, v189
    v_cvt_pk_bf16_f32 v220, v220, v220
    v_and_b32 v220, 0xffff0000, v220
    v_cvt_pk_bf16_f32 v221, v221, v221
    v_and_b32 v221, 0xffff0000, v221
    v_mov_b32 v222, v220
    v_mov_b32 v223, v221
    s_nop 1
    v_permlane32_swap_b32 v220, v222
    v_permlane32_swap_b32 v221, v223
    s_nop 0
    v_mul_f32 v224, 0xbfb8aa3b, v220
    v_exp_f32 v224, v224
    s_nop 0
    v_add_f32 v224, 1.0, v224
    v_rcp_f32 v224, v224
    s_nop 0
    v_mul_f32 v220, v220, v224
    v_cvt_pk_bf16_f32 v220, v220, v220
    v_and_b32 v220, 0xffff0000, v220
    v_mul_f32 v220, v220, v222
    v_cvt_pk_bf16_f32 v220, v220, v220
    v_mul_f32 v224, 0xbfb8aa3b, v221
    v_exp_f32 v224, v224
    s_nop 0
    v_add_f32 v224, 1.0, v224
    v_rcp_f32 v224, v224
    s_nop 0
    v_mul_f32 v221, v221, v224
    v_cvt_pk_bf16_f32 v221, v221, v221
    v_and_b32 v221, 0xffff0000, v221
    v_mul_f32 v221, v221, v223
    v_cvt_pk_bf16_f32 v221, v221, v221
    s_mov_b64 exec, 0xffffffff
    v_mov_b32 v222, v221
    v_mov_b32 v221, v244
    v_mov_b32 v223, v245
    buffer_store_dwordx4 v[220:223], v214, s[44:47], s64 offen sc0 sc1
    s_mov_b64 exec, -1
L_h1s_24:
    s_waitcnt vmcnt(2)
    buffer_load_dwordx4 v[88:91], v2, s[16:19], s55 offen offset:1024 nt
    v_and_b32_dpp v48, v13, v32 row_newbcast:3 row_mask:0xf bank_mask:0xf
    v_and_b32_dpp v49, v13, v33 row_newbcast:3 row_mask:0xf bank_mask:0xf
    v_and_b32_dpp v50, v13, v34 row_newbcast:3 row_mask:0xf bank_mask:0xf
    v_and_b32_dpp v51, v13, v35 row_newbcast:3 row_mask:0xf bank_mask:0xf
    v_mfma_f32_16x16x32_bf16 v[40:43], v[76:79], v[44:47], v[40:43]
    s_waitcnt vmcnt(2)
    buffer_load_dwordx4 v[92:95], v2, s[16:19], s55 offen offset:2048 nt
    v_and_b32_dpp v44, v13, v32 row_newbcast:4 row_mask:0xf bank_mask:0xf
    v_and_b32_dpp v45, v13, v33 row_newbcast:4 row_mask:0xf bank_mask:0xf
    v_and_b32_dpp v46, v13, v34 row_newbcast:4 row_mask:0xf bank_mask:0xf
    v_and_b32_dpp v47, v13, v35 row_newbcast:4 row_mask:0xf bank_mask:0xf
    v_mfma_f32_16x16x32_bf16 v[40:43], v[80:83], v[48:51], v[40:43]
    s_waitcnt vmcnt(2)
    buffer_load_dwordx4 v[96:99], v2, s[16:19], s55 offen offset:3072 nt
    v_and_b32_dpp v48, v13, v32 row_newbcast:5 row_mask:0xf bank_mask:0xf
    v_and_b32_dpp v49, v13, v33 row_newbcast:5 row_mask:0xf bank_mask:0xf
    v_and_b32_dpp v50, v13, v34 row_newbcast:5 row_mask:0xf bank_mask:0xf
    v_and_b32_dpp v51, v13, v35 row_newbcast:5 row_mask:0xf bank_mask:0xf
    v_mfma_f32_16x16x32_bf16 v[40:43], v[84:87], v[44:47], v[40:43]
    s_waitcnt vmcnt(2)
    s_add_u32 s55, s55, 32768
    buffer_load_dwordx4 v[100:103], v2, s[16:19], s55 offen offset:0 nt
    v_and_b32_dpp v44, v13, v32 row_newbcast:6 row_mask:0xf bank_mask:0xf
    v_and_b32_dpp v45, v13, v33 row_newbcast:6 row_mask:0xf bank_mask:0xf
    v_and_b32_dpp v46, v13, v34 row_newbcast:6 row_mask:0xf bank_mask:0xf
    v_and_b32_dpp v47, v13, v35 row_newbcast:6 row_mask:0xf bank_mask:0xf
    v_mfma_f32_16x16x32_bf16 v[40:43], v[88:91], v[48:51], v[40:43]
    s_waitcnt vmcnt(2)
    buffer_load_dwordx4 v[104:107], v2, s[16:19], s55 offen offset:1024 nt
    v_and_b32_dpp v48, v13, v32 row_newbcast:7 row_mask:0xf bank_mask:0xf
    v_and_b32_dpp v49, v13, v33 row_newbcast:7 row_mask:0xf bank_mask:0xf
    v_and_b32_dpp v50, v13, v34 row_newbcast:7 row_mask:0xf bank_mask:0xf
    v_and_b32_dpp v51, v13, v35 row_newbcast:7 row_mask:0xf bank_mask:0xf
    v_mfma_f32_16x16x32_bf16 v[40:43], v[92:95], v[44:47], v[40:43]
    s_waitcnt vmcnt(2)
    buffer_load_dwordx4 v[108:111], v2, s[16:19], s55 offen offset:2048 nt
    v_and_b32_dpp v44, v13, v32 row_newbcast:8 row_mask:0xf bank_mask:0xf
    v_and_b32_dpp v45, v13, v33 row_newbcast:8 row_mask:0xf bank_mask:0xf
    v_and_b32_dpp v46, v13, v34 row_newbcast:8 row_mask:0xf bank_mask:0xf
    v_and_b32_dpp v47, v13, v35 row_newbcast:8 row_mask:0xf bank_mask:0xf
    v_mfma_f32_16x16x32_bf16 v[40:43], v[96:99], v[48:51], v[40:43]
    s_waitcnt vmcnt(2)
    buffer_load_dwordx4 v[112:115], v2, s[16:19], s55 offen offset:3072 nt
    v_and_b32_dpp v48, v13, v32 row_newbcast:9 row_mask:0xf bank_mask:0xf
    v_and_b32_dpp v49, v13, v33 row_newbcast:9 row_mask:0xf bank_mask:0xf
    v_and_b32_dpp v50, v13, v34 row_newbcast:9 row_mask:0xf bank_mask:0xf
    v_and_b32_dpp v51, v13, v35 row_newbcast:9 row_mask:0xf bank_mask:0xf
    v_mfma_f32_16x16x32_bf16 v[40:43], v[100:103], v[44:47], v[40:43]
    s_waitcnt vmcnt(2)
    s_add_u32 s55, s55, 32768
    buffer_load_dwordx4 v[116:119], v2, s[16:19], s55 offen offset:0 nt
    v_and_b32_dpp v44, v13, v32 row_newbcast:10 row_mask:0xf bank_mask:0xf
    v_and_b32_dpp v45, v13, v33 row_newbcast:10 row_mask:0xf bank_mask:0xf
    v_and_b32_dpp v46, v13, v34 row_newbcast:10 row_mask:0xf bank_mask:0xf
    v_and_b32_dpp v47, v13, v35 row_newbcast:10 row_mask:0xf bank_mask:0xf
    v_mfma_f32_16x16x32_bf16 v[40:43], v[104:107], v[48:51], v[40:43]
    s_waitcnt vmcnt(2)
    buffer_load_dwordx4 v[120:123], v2, s[16:19], s55 offen offset:1024 nt
    v_and_b32_dpp v48, v13, v32 row_newbcast:11 row_mask:0xf bank_mask:0xf
    v_and_b32_dpp v49, v13, v33 row_newbcast:11 row_mask:0xf bank_mask:0xf
    v_and_b32_dpp v50, v13, v34 row_newbcast:11 row_mask:0xf bank_mask:0xf
    v_and_b32_dpp v51, v13, v35 row_newbcast:11 row_mask:0xf bank_mask:0xf
    v_mfma_f32_16x16x32_bf16 v[40:43], v[108:111], v[44:47], v[40:43]
    s_waitcnt vmcnt(2)
    buffer_load_dwordx4 v[124:127], v2, s[16:19], s55 offen offset:2048 nt
    v_and_b32_dpp v44, v13, v32 row_newbcast:12 row_mask:0xf bank_mask:0xf
    v_and_b32_dpp v45, v13, v33 row_newbcast:12 row_mask:0xf bank_mask:0xf
    v_and_b32_dpp v46, v13, v34 row_newbcast:12 row_mask:0xf bank_mask:0xf
    v_and_b32_dpp v47, v13, v35 row_newbcast:12 row_mask:0xf bank_mask:0xf
    v_mfma_f32_16x16x32_bf16 v[40:43], v[112:115], v[48:51], v[40:43]
    s_waitcnt vmcnt(2)
    buffer_load_dwordx4 v[128:131], v2, s[16:19], s55 offen offset:3072 nt
    v_and_b32_dpp v48, v13, v32 row_newbcast:13 row_mask:0xf bank_mask:0xf
    v_and_b32_dpp v49, v13, v33 row_newbcast:13 row_mask:0xf bank_mask:0xf
    v_and_b32_dpp v50, v13, v34 row_newbcast:13 row_mask:0xf bank_mask:0xf
    v_and_b32_dpp v51, v13, v35 row_newbcast:13 row_mask:0xf bank_mask:0xf
    v_mfma_f32_16x16x32_bf16 v[40:43], v[116:119], v[44:47], v[40:43]
    s_waitcnt vmcnt(2)
    s_mov_b32 s54, s84
    buffer_load_dwordx4 v[68:71], v2, s[12:15], s54 offen offset:0 nt
    v_and_b32_dpp v44, v13, v32 row_newbcast:14 row_mask:0xf bank_mask:0xf
    v_and_b32_dpp v45, v13, v33 row_newbcast:14 row_mask:0xf bank_mask:0xf
    v_and_b32_dpp v46, v13, v34 row_newbcast:14 row_mask:0xf bank_mask:0xf
    v_and_b32_dpp v47, v13, v35 row_newbcast:14 row_mask:0xf bank_mask:0xf
    v_mfma_f32_16x16x32_bf16 v[40:43], v[120:123], v[48:51], v[40:43]
    s_waitcnt vmcnt(2)
    buffer_load_dwordx4 v[72:75], v2, s[12:15], s54 offen offset:1024 nt
    v_and_b32_dpp v48, v13, v32 row_newbcast:15 row_mask:0xf bank_mask:0xf
    v_and_b32_dpp v49, v13, v33 row_newbcast:15 row_mask:0xf bank_mask:0xf
    v_and_b32_dpp v50, v13, v34 row_newbcast:15 row_mask:0xf bank_mask:0xf
    v_and_b32_dpp v51, v13, v35 row_newbcast:15 row_mask:0xf bank_mask:0xf
    v_mfma_f32_16x16x32_bf16 v[40:43], v[124:127], v[44:47], v[40:43]
    s_waitcnt vmcnt(2)
    buffer_load_dwordx4 v[76:79], v2, s[12:15], s54 offen offset:2048 nt
    s_nop 1
    v_mfma_f32_16x16x32_bf16 v[40:43], v[128:131], v[48:51], v[40:43]
    s_mov_b32 s83, s84
    s_waitcnt vmcnt(2)
    buffer_load_dwordx4 v[80:83], v2, s[12:15], s54 offen offset:3072 nt
    v_dot2_f32_bf16 v52, v68, v36, 0
    v_dot2_f32_bf16 v52, v69, v37, v52
    v_dot2_f32_bf16 v52, v70, v38, v52
    v_dot2_f32_bf16 v52, v71, v39, v52
    s_sub_u32 s57, s3, 4
    s_cmp_ge_u32 s57, 2
    s_cbranch_scc1 L_noh2_25
    s_cmp_ge_u32 s4, 28
    s_cbranch_scc1 L_noh2_25
    s_and_b32 s81, s4, 7
    s_mul_i32 s81, s81, 16896
    s_lshl_b32 s57, s57, 10
    s_add_u32 s57, s57, 12288
    v_lshlrev_b32 v232, 4, v1
    v_add_u32 v232, s57, v232
    s_add_u32 s63, s65, s81
    buffer_load_dwordx4 v[180:183], v232, s[44:47], s63 offen sc1
L_noh2_25:
    s_waitcnt vmcnt(2)
    s_add_u32 s54, s54, 32768
    buffer_load_dwordx4 v[84:87], v2, s[12:15], s54 offen offset:0 nt
    v_dot2_f32_bf16 v53, v72, v36, 0
    v_dot2_f32_bf16 v53, v73, v37, v53
    v_dot2_f32_bf16 v53, v74, v38, v53
    v_dot2_f32_bf16 v53, v75, v39, v53
    s_waitcnt vmcnt(2)
    buffer_load_dwordx4 v[88:91], v2, s[12:15], s54 offen offset:1024 nt
    buffer_load_dwordx4 v[148:151], v5, s[36:39], s67 offen nt
    s_add_u32 s63, s67, 8192
    buffer_load_dwordx4 v[152:155], v5, s[36:39], s63 offen nt
    s_add_u32 s63, s67, 16384
    buffer_load_dwordx4 v[156:159], v5, s[36:39], s63 offen nt
    s_add_u32 s63, s67, 24576
    buffer_load_dwordx4 v[160:163], v5, s[36:39], s63 offen nt
    v_and_b32 v22, 3, v1
    v_lshlrev_b32 v22, 2, v22
    s_lshl_b32 s57, s2, 4
    buffer_load_dword v10, v22, s[8:11], s57 offen
    v_dot2_f32_bf16 v54, v76, v36, 0
    v_dot2_f32_bf16 v54, v77, v37, v54
    v_dot2_f32_bf16 v54, v78, v38, v54
    v_dot2_f32_bf16 v54, v79, v39, v54
    s_waitcnt vmcnt(7)
    buffer_load_dwordx4 v[92:95], v2, s[12:15], s54 offen offset:2048 nt
    v_dot2_f32_bf16 v55, v80, v36, 0
    v_dot2_f32_bf16 v55, v81, v37, v55
    v_dot2_f32_bf16 v55, v82, v38, v55
    v_dot2_f32_bf16 v55, v83, v39, v55
    s_waitcnt vmcnt(7)
    buffer_load_dwordx4 v[96:99], v2, s[12:15], s54 offen offset:3072 nt
    v_dot2_f32_bf16 v56, v84, v36, 0
    v_dot2_f32_bf16 v56, v85, v37, v56
    v_dot2_f32_bf16 v56, v86, v38, v56
    v_dot2_f32_bf16 v56, v87, v39, v56
    s_waitcnt vmcnt(7)
    s_add_u32 s54, s54, 32768
    buffer_load_dwordx4 v[100:103], v2, s[12:15], s54 offen offset:0 nt
    v_dot2_f32_bf16 v57, v88, v36, 0
    v_dot2_f32_bf16 v57, v89, v37, v57
    v_dot2_f32_bf16 v57, v90, v38, v57
    v_dot2_f32_bf16 v57, v91, v39, v57
    s_waitcnt vmcnt(2)
    buffer_load_dwordx4 v[104:107], v2, s[12:15], s54 offen offset:1024 nt
    v_dot2_f32_bf16 v58, v92, v36, 0
    v_dot2_f32_bf16 v58, v93, v37, v58
    v_dot2_f32_bf16 v58, v94, v38, v58
    v_dot2_f32_bf16 v58, v95, v39, v58
    s_waitcnt vmcnt(2)
    buffer_load_dwordx4 v[108:111], v2, s[12:15], s54 offen offset:2048 nt
    v_dot2_f32_bf16 v59, v96, v36, 0
    v_dot2_f32_bf16 v59, v97, v37, v59
    v_dot2_f32_bf16 v59, v98, v38, v59
    v_dot2_f32_bf16 v59, v99, v39, v59
    s_waitcnt vmcnt(2)
    buffer_load_dwordx4 v[112:115], v2, s[12:15], s54 offen offset:3072 nt
    v_dot2_f32_bf16 v60, v100, v36, 0
    v_dot2_f32_bf16 v60, v101, v37, v60
    v_dot2_f32_bf16 v60, v102, v38, v60
    v_dot2_f32_bf16 v60, v103, v39, v60
    s_sub_u32 s57, s3, 4
    s_cmp_ge_u32 s57, 2
    s_cbranch_scc1 L_noh3_26
    s_cmp_ge_u32 s4, 28
    s_cbranch_scc1 L_noh3_26
    s_mov_b32 s66, 200000
L_chk_27:
    v_cmpx_eq_u32 vcc, v181, v244
    v_cmpx_eq_u32 vcc, v183, v245
    s_nop 1
    s_mov_b64 s[98:99], exec
    s_mov_b64 exec, -1
    s_cmp_eq_u64 s[98:99], -1
    s_cbranch_scc1 L_ok_28
    s_sub_u32 s66, s66, 1
    s_cbranch_scc1 L_ok_28
    s_add_u32 s63, s65, s81
    buffer_load_dwordx4 v[180:183], v232, s[44:47], s63 offen sc1
    s_waitcnt vmcnt(0)
    s_branch L_chk_27
L_ok_28:
    s_sub_u32 s57, s3, 4
    s_lshl_b32 s57, s57, 9
    s_add_u32 s57, s57, 1024
    v_add_u32 v225, s57, v9
    ds_write2_b32 v225, v180, v182 offset0:0 offset1:4
    s_waitcnt lgkmcnt(0)
    v_mov_b32 v226, 0
    v_mov_b32 v227, 1
    s_mov_b64 exec, 1
    ds_add_u32 v226, v227 offset:3588
    s_mov_b64 exec, -1
L_noh3_26:
    s_waitcnt vmcnt(2)
    s_add_u32 s54, s54, 32768
    buffer_load_dwordx4 v[116:119], v2, s[12:15], s54 offen offset:0 nt
    v_dot2_f32_bf16 v61, v104, v36, 0
    v_dot2_f32_bf16 v61, v105, v37, v61
    v_dot2_f32_bf16 v61, v106, v38, v61
    v_dot2_f32_bf16 v61, v107, v39, v61
    s_waitcnt vmcnt(2)
    buffer_load_dwordx4 v[120:123], v2, s[12:15], s54 offen offset:1024 nt
    s_lshl_b32 s57, s86, 2
    v_mov_b32 v240, s57
    v_mov_b32 v250, 1
    s_mov_b64 exec, 1
    ds_add_rtn_u32 v241, v240, v250 offset:3648
    s_waitcnt lgkmcnt(0)
    s_mov_b64 exec, -1
    v_readfirstlane_b32 s88, v241
    s_nop 0
    s_cmp_lg_u32 s88, 0
    s_cbranch_scc1 L_tk_29
    s_mov_b64 exec, 1
    buffer_atomic_add v250, off, s[44:47], s85 sc0
    s_mov_b64 exec, -1
L_tk_29:
    v_dot2_f32_bf16 v62, v108, v36, 0
    v_dot2_f32_bf16 v62, v109, v37, v62
    v_dot2_f32_bf16 v62, v110, v38, v62
    v_dot2_f32_bf16 v62, v111, v39, v62
    s_waitcnt vmcnt(2)
    buffer_load_dwordx4 v[124:127], v2, s[12:15], s54 offen offset:2048 nt
    v_dot2_f32_bf16 v63, v112, v36, 0
    v_dot2_f32_bf16 v63, v113, v37, v63
    v_dot2_f32_bf16 v63, v114, v38, v63
    v_dot2_f32_bf16 v63, v115, v39, v63
    s_waitcnt vmcnt(2)
    buffer_load_dwordx4 v[128:131], v2, s[12:15], s54 offen offset:3072 nt
    v_dot2_f32_bf16 v64, v116, v36, 0
    v_dot2_f32_bf16 v64, v117, v37, v64
    v_dot2_f32_bf16 v64, v118, v38, v64
    v_dot2_f32_bf16 v64, v119, v39, v64
    s_waitcnt vmcnt(2)
    s_mov_b32 s55, s83
    buffer_load_dwordx4 v[68:71], v2, s[16:19], s55 offen offset:0 nt
    v_dot2_f32_bf16 v65, v120, v36, 0
    v_dot2_f32_bf16 v65, v121, v37, v65
    v_dot2_f32_bf16 v65, v122, v38, v65
    v_dot2_f32_bf16 v65, v123, v39, v65
    s_waitcnt vmcnt(2)
    buffer_load_dwordx4 v[72:75], v2, s[16:19], s55 offen offset:1024 nt
    v_dot2_f32_bf16 v66, v124, v36, 0
    v_dot2_f32_bf16 v66, v125, v37, v66
    v_dot2_f32_bf16 v66, v126, v38, v66
    v_dot2_f32_bf16 v66, v127, v39, v66
    s_cmp_ge_u32 s4, 28
    s_cbranch_scc1 L_f2skip_30
    v_mov_b32 v212, 0
L_f2cnt_31:
    ds_read_b32 v213, v212 offset:3588
    s_waitcnt lgkmcnt(0)
    v_readfirstlane_b32 s57, v213
    s_nop 0
    s_cmp_lt_u32 s57, 2
    s_cbranch_scc1 L_f2cnt_31
    ds_read_b128 v[212:215], v6 offset:1024
    s_waitcnt lgkmcnt(0)
    v_and_b32 v44, v212, v32
    v_and_b32 v45, v212, v33
    v_and_b32 v46, v212, v34
    v_and_b32 v47, v212, v35
    v_and_b32 v48, v213, v32
    v_and_b32 v49, v213, v33
    v_and_b32 v50, v213, v34
    v_and_b32 v51, v213, v35
    v_mfma_f32_16x16x32_bf16 v[216:219], v[148:151], v[44:47], 0
    v_and_b32 v44, v214, v32
    v_and_b32 v45, v214, v33
    v_and_b32 v46, v214, v34
    v_and_b32 v47, v214, v35
    v_mfma_f32_16x16x32_bf16 v[216:219], v[152:155], v[48:51], v[216:219]
    v_and_b32 v48, v215, v32
    v_and_b32 v49, v215, v33
    v_and_b32 v50, v215, v34
    v_and_b32 v51, v215, v35
    v_mfma_f32_16x16x32_bf16 v[216:219], v[156:159], v[44:47], v[216:219]
    s_nop 1
    v_mfma_f32_16x16x32_bf16 v[216:219], v[160:163], v[48:51], v[216:219]
    s_nop 7
    ds_write_b128 v7, v[216:219] offset:12288
L_f2skip_30:
    s_waitcnt vmcnt(2)
    buffer_load_dwordx4 v[76:79], v2, s[16:19], s55 offen offset:2048 nt
    s_cmp_lg_u32 s88, 0
    s_cbranch_scc1 L_sh_32
    v_add_u32 v250, 1, v250
    s_mov_b64 exec, 1
    ds_write_b32 v240, v250 offset:3712
    s_mov_b64 exec, -1
L_sh_32:
    v_dot2_f32_bf16 v67, v128, v36, 0
    v_dot2_f32_bf16 v67, v129, v37, v67
    v_dot2_f32_bf16 v67, v130, v38, v67
    v_dot2_f32_bf16 v67, v131, v39, v67
    s_nop 2
    v_add_f32_dpp v52, v52, v52 row_ror:8 row_mask:0xf bank_mask:0x3
    v_add_f32_dpp v53, v53, v53 row_ror:8 row_mask:0xf bank_mask:0x3
    v_add_f32_dpp v54, v54, v54 row_ror:8 row_mask:0xf bank_mask:0x3
    v_add_f32_dpp v55, v55, v55 row_ror:8 row_mask:0xf bank_mask:0x3
    v_add_f32_dpp v56, v56, v56 row_ror:8 row_mask:0xf bank_mask:0x3
    v_add_f32_dpp v57, v57, v57 row_ror:8 row_mask:0xf bank_mask:0x3
    v_add_f32_dpp v58, v58, v58 row_ror:8 row_mask:0xf bank_mask:0x3
    v_add_f32_dpp v59, v59, v59 row_ror:8 row_mask:0xf bank_mask:0x3
    v_add_f32_dpp v52, v60, v60 row_ror:8 row_mask:0xf bank_mask:0xc
    v_add_f32_dpp v53, v61, v61 row_ror:8 row_mask:0xf bank_mask:0xc
    v_add_f32_dpp v54, v62, v62 row_ror:8 row_mask:0xf bank_mask:0xc
    v_add_f32_dpp v55, v63, v63 row_ror:8 row_mask:0xf bank_mask:0xc
    v_add_f32_dpp v56, v64, v64 row_ror:8 row_mask:0xf bank_mask:0xc
    v_add_f32_dpp v57, v65, v65 row_ror:8 row_mask:0xf bank_mask:0xc
    v_add_f32_dpp v58, v66, v66 row_ror:8 row_mask:0xf bank_mask:0xc
    v_add_f32_dpp v59, v67, v67 row_ror:8 row_mask:0xf bank_mask:0xc
    v_add_f32_dpp v52, v52, v52 row_ror:12 row_mask:0xf bank_mask:0x5
    v_add_f32_dpp v53, v53, v53 row_ror:12 row_mask:0xf bank_mask:0x5
    v_add_f32_dpp v54, v54, v54 row_ror:12 row_mask:0xf bank_mask:0x5
    v_add_f32_dpp v55, v55, v55 row_ror:12 row_mask:0xf bank_mask:0x5
    v_add_f32_dpp v52, v56, v56 row_ror:4 row_mask:0xf bank_mask:0xa
    v_add_f32_dpp v53, v57, v57 row_ror:4 row_mask:0xf bank_mask:0xa
    v_add_f32_dpp v54, v58, v58 row_ror:4 row_mask:0xf bank_mask:0xa
    v_add_f32_dpp v55, v59, v59 row_ror:4 row_mask:0xf bank_mask:0xa
    v_add_f32_dpp v60, v52, v52 quad_perm:[2,3,0,1] row_mask:0xf bank_mask:0xf
    v_add_f32_dpp v61, v53, v53 quad_perm:[2,3,0,1] row_mask:0xf bank_mask:0xf
    v_add_f32_dpp v62, v54, v54 quad_perm:[2,3,0,1] row_mask:0xf bank_mask:0xf
    v_add_f32_dpp v63, v55, v55 quad_perm:[2,3,0,1] row_mask:0xf bank_mask:0xf
    v_cndmask_b32_e64 v52, v60, v62, s[96:97]
    v_cndmask_b32_e64 v53, v61, v63, s[96:97]
    s_nop 0
    v_add_f32_dpp v60, v52, v52 quad_perm:[1,0,3,2] row_mask:0xf bank_mask:0xf
    v_add_f32_dpp v61, v53, v53 quad_perm:[1,0,3,2] row_mask:0xf bank_mask:0xf
    v_cndmask_b32_e64 v14, v60, v61, s[94:95]
    v_cvt_pk_bf16_f32 v14, v14, v14
    v_and_b32 v14, 0xffff0000, v14
    v_mul_f32 v14, 0x3db504f3, v14
    v_cvt_pk_bf16_f32 v14, v14, v14
    v_and_b32 v14, 0xffff0000, v14
    v_mov_b32 v15, v14
    s_nop 1
    v_max_f32_dpp v15, v15, v15 row_ror:8 row_mask:0xf bank_mask:0xf
    s_nop 1
    v_max_f32_dpp v15, v15, v15 row_ror:4 row_mask:0xf bank_mask:0xf
    s_nop 1
    v_max_f32_dpp v15, v15, v15 row_ror:2 row_mask:0xf bank_mask:0xf
    s_nop 1
    v_max_f32_dpp v15, v15, v15 row_ror:1 row_mask:0xf bank_mask:0xf
    v_mov_b32 v16, v15
    s_nop 1
    v_permlane16_swap_b32 v15, v16
    s_nop 0
    v_max_f32 v15, v15, v16
    v_mov_b32 v16, v15
    s_nop 1
    v_permlane32_swap_b32 v15, v16
    s_nop 0
    v_max_f32 v15, v15, v16
    v_max_f32 v15, v15, v11
    v_sub_f32 v16, v11, v15
    v_sub_f32 v14, v14, v15
    v_mul_f32 v16, 0x3fb8aa3b, v16
    v_mul_f32 v14, 0x3fb8aa3b, v14
    v_exp_f32 v16, v16
    v_exp_f32 v14, v14
    v_mov_b32 v11, v15
    v_cvt_pk_bf16_f32 v13, v14, v14
    v_fma_f32 v12, v12, v16, v14
    v_mul_f32 v40, v16, v40
    v_mul_f32 v41, v16, v41
    v_mul_f32 v42, v16, v42
    v_mul_f32 v43, v16, v43
    v_and_b32_dpp v44, v13, v32 row_newbcast:0 row_mask:0xf bank_mask:0xf
    v_and_b32_dpp v45, v13, v33 row_newbcast:0 row_mask:0xf bank_mask:0xf
    v_and_b32_dpp v46, v13, v34 row_newbcast:0 row_mask:0xf bank_mask:0xf
    v_and_b32_dpp v47, v13, v35 row_newbcast:0 row_mask:0xf bank_mask:0xf
    s_waitcnt vmcnt(2)
    buffer_load_dwordx4 v[80:83], v2, s[16:19], s55 offen offset:3072 nt
    v_and_b32_dpp v48, v13, v32 row_newbcast:1 row_mask:0xf bank_mask:0xf
    v_and_b32_dpp v49, v13, v33 row_newbcast:1 row_mask:0xf bank_mask:0xf
    v_and_b32_dpp v50, v13, v34 row_newbcast:1 row_mask:0xf bank_mask:0xf
    v_and_b32_dpp v51, v13, v35 row_newbcast:1 row_mask:0xf bank_mask:0xf
    v_mfma_f32_16x16x32_bf16 v[40:43], v[68:71], v[44:47], v[40:43]
    s_waitcnt vmcnt(2)
    s_add_u32 s55, s55, 32768
    buffer_load_dwordx4 v[84:87], v2, s[16:19], s55 offen offset:0 nt
    v_and_b32_dpp v44, v13, v32 row_newbcast:2 row_mask:0xf bank_mask:0xf
    v_and_b32_dpp v45, v13, v33 row_newbcast:2 row_mask:0xf bank_mask:0xf
    v_and_b32_dpp v46, v13, v34 row_newbcast:2 row_mask:0xf bank_mask:0xf
    v_and_b32_dpp v47, v13, v35 row_newbcast:2 row_mask:0xf bank_mask:0xf
    v_mfma_f32_16x16x32_bf16 v[40:43], v[72:75], v[48:51], v[40:43]
    s_waitcnt vmcnt(2)
    buffer_load_dwordx4 v[88:91], v2, s[16:19], s55 offen offset:1024 nt
    v_and_b32_dpp v48, v13, v32 row_newbcast:3 row_mask:0xf bank_mask:0xf
    v_and_b32_dpp v49, v13, v33 row_newbcast:3 row_mask:0xf bank_mask:0xf
    v_and_b32_dpp v50, v13, v34 row_newbcast:3 row_mask:0xf bank_mask:0xf
    v_and_b32_dpp v51, v13, v35 row_newbcast:3 row_mask:0xf bank_mask:0xf
    v_mfma_f32_16x16x32_bf16 v[40:43], v[76:79], v[44:47], v[40:43]
    s_waitcnt vmcnt(2)
    buffer_load_dwordx4 v[92:95], v2, s[16:19], s55 offen offset:2048 nt
    v_and_b32_dpp v44, v13, v32 row_newbcast:4 row_mask:0xf bank_mask:0xf
    v_and_b32_dpp v45, v13, v33 row_newbcast:4 row_mask:0xf bank_mask:0xf
    v_and_b32_dpp v46, v13, v34 row_newbcast:4 row_mask:0xf bank_mask:0xf
    v_and_b32_dpp v47, v13, v35 row_newbcast:4 row_mask:0xf bank_mask:0xf
    v_mfma_f32_16x16x32_bf16 v[40:43], v[80:83], v[48:51], v[40:43]
    s_waitcnt vmcnt(2)
    buffer_load_dwordx4 v[96:99], v2, s[16:19], s55 offen offset:3072 nt
    v_and_b32_dpp v48, v13, v32 row_newbcast:5 row_mask:0xf bank_mask:0xf
    v_and_b32_dpp v49, v13, v33 row_newbcast:5 row_mask:0xf bank_mask:0xf
    v_and_b32_dpp v50, v13, v34 row_newbcast:5 row_mask:0xf bank_mask:0xf
    v_and_b32_dpp v51, v13, v35 row_newbcast:5 row_mask:0xf bank_mask:0xf
    v_mfma_f32_16x16x32_bf16 v[40:43], v[84:87], v[44:47], v[40:43]
L_DEC:
L_db_33:
    ds_read_b32 v241, v240 offset:3712
    s_waitcnt lgkmcnt(0)
    v_readfirstlane_b32 s57, v241
    s_nop 0
    s_cmp_eq_u32 s57, 0
    s_cbranch_scc1 L_db_33
    s_sub_u32 s57, s57, 1
    s_add_u32 s86, s86, 1
    s_and_b32 s58, s57, 3
    s_lshl_b32 s58, s58, 20
    s_lshr_b32 s59, s57, 2
    s_lshl_b32 s59, s59, 17
    s_add_u32 s58, s58, s59
    s_lshl_b32 s59, s3, 12
    s_add_u32 s58, s58, s59
    s_add_u32 s58, s58, s76
    s_add_u32 s84, s58, 786432
    s_cmp_lt_u32 s57, 5
    s_cbranch_scc0 L_LAST
    s_waitcnt vmcnt(2)
    s_add_u32 s55, s55, 32768
    buffer_load_dwordx4 v[100:103], v2, s[16:19], s55 offen offset:0 nt
    v_and_b32_dpp v44, v13, v32 row_newbcast:6 row_mask:0xf bank_mask:0xf
    v_and_b32_dpp v45, v13, v33 row_newbcast:6 row_mask:0xf bank_mask:0xf
    v_and_b32_dpp v46, v13, v34 row_newbcast:6 row_mask:0xf bank_mask:0xf
    v_and_b32_dpp v47, v13, v35 row_newbcast:6 row_mask:0xf bank_mask:0xf
    v_mfma_f32_16x16x32_bf16 v[40:43], v[88:91], v[48:51], v[40:43]
    s_waitcnt vmcnt(2)
    buffer_load_dwordx4 v[104:107], v2, s[16:19], s55 offen offset:1024 nt
    v_and_b32_dpp v48, v13, v32 row_newbcast:7 row_mask:0xf bank_mask:0xf
    v_and_b32_dpp v49, v13, v33 row_newbcast:7 row_mask:0xf bank_mask:0xf
    v_and_b32_dpp v50, v13, v34 row_newbcast:7 row_mask:0xf bank_mask:0xf
    v_and_b32_dpp v51, v13, v35 row_newbcast:7 row_mask:0xf bank_mask:0xf
    v_mfma_f32_16x16x32_bf16 v[40:43], v[92:95], v[44:47], v[40:43]
    s_waitcnt vmcnt(2)
    buffer_load_dwordx4 v[108:111], v2, s[16:19], s55 offen offset:2048 nt
    v_and_b32_dpp v44, v13, v32 row_newbcast:8 row_mask:0xf bank_mask:0xf
    v_and_b32_dpp v45, v13, v33 row_newbcast:8 row_mask:0xf bank_mask:0xf
    v_and_b32_dpp v46, v13, v34 row_newbcast:8 row_mask:0xf bank_mask:0xf
    v_and_b32_dpp v47, v13, v35 row_newbcast:8 row_mask:0xf bank_mask:0xf
    v_mfma_f32_16x16x32_bf16 v[40:43], v[96:99], v[48:51], v[40:43]
    s_waitcnt vmcnt(2)
    buffer_load_dwordx4 v[112:115], v2, s[16:19], s55 offen offset:3072 nt
    v_and_b32_dpp v48, v13, v32 row_newbcast:9 row_mask:0xf bank_mask:0xf
    v_and_b32_dpp v49, v13, v33 row_newbcast:9 row_mask:0xf bank_mask:0xf
    v_and_b32_dpp v50, v13, v34 row_newbcast:9 row_mask:0xf bank_mask:0xf
    v_and_b32_dpp v51, v13, v35 row_newbcast:9 row_mask:0xf bank_mask:0xf
    v_mfma_f32_16x16x32_bf16 v[40:43], v[100:103], v[44:47], v[40:43]
    s_waitcnt vmcnt(2)
    s_add_u32 s55, s55, 32768
    buffer_load_dwordx4 v[116:119], v2, s[16:19], s55 offen offset:0 nt
    v_and_b32_dpp v44, v13, v32 row_newbcast:10 row_mask:0xf bank_mask:0xf
    v_and_b32_dpp v45, v13, v33 row_newbcast:10 row_mask:0xf bank_mask:0xf
    v_and_b32_dpp v46, v13, v34 row_newbcast:10 row_mask:0xf bank_mask:0xf
    v_and_b32_dpp v47, v13, v35 row_newbcast:10 row_mask:0xf bank_mask:0xf
    v_mfma_f32_16x16x32_bf16 v[40:43], v[104:107], v[48:51], v[40:43]
    s_waitcnt vmcnt(2)
    buffer_load_dwordx4 v[120:123], v2, s[16:19], s55 offen offset:1024 nt
    v_and_b32_dpp v48, v13, v32 row_newbcast:11 row_mask:0xf bank_mask:0xf
    v_and_b32_dpp v49, v13, v33 row_newbcast:11 row_mask:0xf bank_mask:0xf
    v_and_b32_dpp v50, v13, v34 row_newbcast:11 row_mask:0xf bank_mask:0xf
    v_and_b32_dpp v51, v13, v35 row_newbcast:11 row_mask:0xf bank_mask:0xf
    v_mfma_f32_16x16x32_bf16 v[40:43], v[108:111], v[44:47], v[40:43]
    s_waitcnt vmcnt(2)
    buffer_load_dwordx4 v[124:127], v2, s[16:19], s55 offen offset:2048 nt
    v_and_b32_dpp v44, v13, v32 row_newbcast:12 row_mask:0xf bank_mask:0xf
    v_and_b32_dpp v45, v13, v33 row_newbcast:12 row_mask:0xf bank_mask:0xf
    v_and_b32_dpp v46, v13, v34 row_newbcast:12 row_mask:0xf bank_mask:0xf
    v_and_b32_dpp v47, v13, v35 row_newbcast:12 row_mask:0xf bank_mask:0xf
    v_mfma_f32_16x16x32_bf16 v[40:43], v[112:115], v[48:51], v[40:43]
    s_waitcnt vmcnt(2)
    buffer_load_dwordx4 v[128:131], v2, s[16:19], s55 offen offset:3072 nt
    v_and_b32_dpp v48, v13, v32 row_newbcast:13 row_mask:0xf bank_mask:0xf
    v_and_b32_dpp v49, v13, v33 row_newbcast:13 row_mask:0xf bank_mask:0xf
    v_and_b32_dpp v50, v13, v34 row_newbcast:13 row_mask:0xf bank_mask:0xf
    v_and_b32_dpp v51, v13, v35 row_newbcast:13 row_mask:0xf bank_mask:0xf
    v_mfma_f32_16x16x32_bf16 v[40:43], v[116:119], v[44:47], v[40:43]
    s_waitcnt vmcnt(2)
    s_mov_b32 s54, s84
    buffer_load_dwordx4 v[68:71], v2, s[12:15], s54 offen offset:0 nt
    v_and_b32_dpp v44, v13, v32 row_newbcast:14 row_mask:0xf bank_mask:0xf
    v_and_b32_dpp v45, v13, v33 row_newbcast:14 row_mask:0xf bank_mask:0xf
    v_and_b32_dpp v46, v13, v34 row_newbcast:14 row_mask:0xf bank_mask:0xf
    v_and_b32_dpp v47, v13, v35 row_newbcast:14 row_mask:0xf bank_mask:0xf
    v_mfma_f32_16x16x32_bf16 v[40:43], v[120:123], v[48:51], v[40:43]
    s_waitcnt vmcnt(2)
    buffer_load_dwordx4 v[72:75], v2, s[12:15], s54 offen offset:1024 nt
    v_and_b32_dpp v48, v13, v32 row_newbcast:15 row_mask:0xf bank_mask:0xf
    v_and_b32_dpp v49, v13, v33 row_newbcast:15 row_mask:0xf bank_mask:0xf
    v_and_b32_dpp v50, v13, v34 row_newbcast:15 row_mask:0xf bank_mask:0xf
    v_and_b32_dpp v51, v13, v35 row_newbcast:15 row_mask:0xf bank_mask:0xf
    v_mfma_f32_16x16x32_bf16 v[40:43], v[124:127], v[44:47], v[40:43]
    s_waitcnt vmcnt(2)
    buffer_load_dwordx4 v[76:79], v2, s[12:15], s54 offen offset:2048 nt
    s_nop 1
    v_mfma_f32_16x16x32_bf16 v[40:43], v[128:131], v[48:51], v[40:43]
    s_mov_b32 s83, s84
    s_waitcnt vmcnt(2)
    buffer_load_dwordx4 v[80:83], v2, s[12:15], s54 offen offset:3072 nt
    v_dot2_f32_bf16 v52, v68, v36, 0
    v_dot2_f32_bf16 v52, v69, v37, v52
    v_dot2_f32_bf16 v52, v70, v38, v52
    v_dot2_f32_bf16 v52, v71, v39, v52
    s_waitcnt vmcnt(2)
    s_add_u32 s54, s54, 32768
    buffer_load_dwordx4 v[84:87], v2, s[12:15], s54 offen offset:0 nt
    v_dot2_f32_bf16 v53, v72, v36, 0
    v_dot2_f32_bf16 v53, v73, v37, v53
    v_dot2_f32_bf16 v53, v74, v38, v53
    v_dot2_f32_bf16 v53, v75, v39, v53
    s_waitcnt vmcnt(2)
    buffer_load_dwordx4 v[88:91], v2, s[12:15], s54 offen offset:1024 nt
    v_dot2_f32_bf16 v54, v76, v36, 0
    v_dot2_f32_bf16 v54, v77, v37, v54
    v_dot2_f32_bf16 v54, v78, v38, v54
    v_dot2_f32_bf16 v54, v79, v39, v54
    s_waitcnt vmcnt(2)
    buffer_load_dwordx4 v[92:95], v2, s[12:15], s54 offen offset:2048 nt
    v_dot2_f32_bf16 v55, v80, v36, 0
    v_dot2_f32_bf16 v55, v81, v37, v55
    v_dot2_f32_bf16 v55, v82, v38, v55
    v_dot2_f32_bf16 v55, v83, v39, v55
    s_waitcnt vmcnt(2)
    buffer_load_dwordx4 v[96:99], v2, s[12:15], s54 offen offset:3072 nt
    v_dot2_f32_bf16 v56, v84, v36, 0
    v_dot2_f32_bf16 v56, v85, v37, v56
    v_dot2_f32_bf16 v56, v86, v38, v56
    v_dot2_f32_bf16 v56, v87, v39, v56
    s_waitcnt vmcnt(2)
    s_add_u32 s54, s54, 32768
    buffer_load_dwordx4 v[100:103], v2, s[12:15], s54 offen offset:0 nt
    v_dot2_f32_bf16 v57, v88, v36, 0
    v_dot2_f32_bf16 v57, v89, v37, v57
    v_dot2_f32_bf16 v57, v90, v38, v57
    v_dot2_f32_bf16 v57, v91, v39, v57
    s_waitcnt vmcnt(2)
    buffer_load_dwordx4 v[104:107], v2, s[12:15], s54 offen offset:1024 nt
    v_dot2_f32_bf16 v58, v92, v36, 0
    v_dot2_f32_bf16 v58, v93, v37, v58
    v_dot2_f32_bf16 v58, v94, v38, v58
    v_dot2_f32_bf16 v58, v95, v39, v58
    s_waitcnt vmcnt(2)
    buffer_load_dwordx4 v[108:111], v2, s[12:15], s54 offen offset:2048 nt
    v_dot2_f32_bf16 v59, v96, v36, 0
    v_dot2_f32_bf16 v59, v97, v37, v59
    v_dot2_f32_bf16 v59, v98, v38, v59
    v_dot2_f32_bf16 v59, v99, v39, v59
    s_waitcnt vmcnt(2)
    buffer_load_dwordx4 v[112:115], v2, s[12:15], s54 offen offset:3072 nt
    v_dot2_f32_bf16 v60, v100, v36, 0
    v_dot2_f32_bf16 v60, v101, v37, v60
    v_dot2_f32_bf16 v60, v102, v38, v60
    v_dot2_f32_bf16 v60, v103, v39, v60
    s_waitcnt vmcnt(2)
    s_add_u32 s54, s54, 32768
    buffer_load_dwordx4 v[116:119], v2, s[12:15], s54 offen offset:0 nt
    v_dot2_f32_bf16 v61, v104, v36, 0
    v_dot2_f32_bf16 v61, v105, v37, v61
    v_dot2_f32_bf16 v61, v106, v38, v61
    v_dot2_f32_bf16 v61, v107, v39, v61
    s_waitcnt vmcnt(2)
    buffer_load_dwordx4 v[120:123], v2, s[12:15], s54 offen offset:1024 nt
    s_lshl_b32 s57, s86, 2
    v_mov_b32 v240, s57
    v_mov_b32 v250, 1
    s_mov_b64 exec, 1
    ds_add_rtn_u32 v241, v240, v250 offset:3648
    s_waitcnt lgkmcnt(0)
    s_mov_b64 exec, -1
    v_readfirstlane_b32 s88, v241
    s_nop 0
    s_cmp_lg_u32 s88, 0
    s_cbranch_scc1 L_tk_34
    s_mov_b64 exec, 1
    buffer_atomic_add v250, off, s[44:47], s85 sc0
    s_mov_b64 exec, -1
L_tk_34:
    v_dot2_f32_bf16 v62, v108, v36, 0
    v_dot2_f32_bf16 v62, v109, v37, v62
    v_dot2_f32_bf16 v62, v110, v38, v62
    v_dot2_f32_bf16 v62, v111, v39, v62
    s_waitcnt vmcnt(2)
    buffer_load_dwordx4 v[124:127], v2, s[12:15], s54 offen offset:2048 nt
    v_dot2_f32_bf16 v63, v112, v36, 0
    v_dot2_f32_bf16 v63, v113, v37, v63
    v_dot2_f32_bf16 v63, v114, v38, v63
    v_dot2_f32_bf16 v63, v115, v39, v63
    s_waitcnt vmcnt(2)
    buffer_load_dwordx4 v[128:131], v2, s[12:15], s54 offen offset:3072 nt
    v_dot2_f32_bf16 v64, v116, v36, 0
    v_dot2_f32_bf16 v64, v117, v37, v64
    v_dot2_f32_bf16 v64, v118, v38, v64
    v_dot2_f32_bf16 v64, v119, v39, v64
    s_waitcnt vmcnt(2)
    s_mov_b32 s55, s83
    buffer_load_dwordx4 v[68:71], v2, s[16:19], s55 offen offset:0 nt
    v_dot2_f32_bf16 v65, v120, v36, 0
    v_dot2_f32_bf16 v65, v121, v37, v65
    v_dot2_f32_bf16 v65, v122, v38, v65
    v_dot2_f32_bf16 v65, v123, v39, v65
    s_waitcnt vmcnt(2)
    buffer_load_dwordx4 v[72:75], v2, s[16:19], s55 offen offset:1024 nt
    v_dot2_f32_bf16 v66, v124, v36, 0
    v_dot2_f32_bf16 v66, v125, v37, v66
    v_dot2_f32_bf16 v66, v126, v38, v66
    v_dot2_f32_bf16 v66, v127, v39, v66
    s_waitcnt vmcnt(2)
    buffer_load_dwordx4 v[76:79], v2, s[16:19], s55 offen offset:2048 nt
    s_cmp_lg_u32 s88, 0
    s_cbranch_scc1 L_sh_35
    v_add_u32 v250, 1, v250
    s_mov_b64 exec, 1
    ds_write_b32 v240, v250 offset:3712
    s_mov_b64 exec, -1
L_sh_35:
    v_dot2_f32_bf16 v67, v128, v36, 0
    v_dot2_f32_bf16 v67, v129, v37, v67
    v_dot2_f32_bf16 v67, v130, v38, v67
    v_dot2_f32_bf16 v67, v131, v39, v67
    s_nop 2
    v_add_f32_dpp v52, v52, v52 row_ror:8 row_mask:0xf bank_mask:0x3
    v_add_f32_dpp v53, v53, v53 row_ror:8 row_mask:0xf bank_mask:0x3
    v_add_f32_dpp v54, v54, v54 row_ror:8 row_mask:0xf bank_mask:0x3
    v_add_f32_dpp v55, v55, v55 row_ror:8 row_mask:0xf bank_mask:0x3
    v_add_f32_dpp v56, v56, v56 row_ror:8 row_mask:0xf bank_mask:0x3
    v_add_f32_dpp v57, v57, v57 row_ror:8 row_mask:0xf bank_mask:0x3
    v_add_f32_dpp v58, v58, v58 row_ror:8 row_mask:0xf bank_mask:0x3
    v_add_f32_dpp v59, v59, v59 row_ror:8 row_mask:0xf bank_mask:0x3
    v_add_f32_dpp v52, v60, v60 row_ror:8 row_mask:0xf bank_mask:0xc
    v_add_f32_dpp v53, v61, v61 row_ror:8 row_mask:0xf bank_mask:0xc
    v_add_f32_dpp v54, v62, v62 row_ror:8 row_mask:0xf bank_mask:0xc
    v_add_f32_dpp v55, v63, v63 row_ror:8 row_mask:0xf bank_mask:0xc
    v_add_f32_dpp v56, v64, v64 row_ror:8 row_mask:0xf bank_mask:0xc
    v_add_f32_dpp v57, v65, v65 row_ror:8 row_mask:0xf bank_mask:0xc
    v_add_f32_dpp v58, v66, v66 row_ror:8 row_mask:0xf bank_mask:0xc
    v_add_f32_dpp v59, v67, v67 row_ror:8 row_mask:0xf bank_mask:0xc
    v_add_f32_dpp v52, v52, v52 row_ror:12 row_mask:0xf bank_mask:0x5
    v_add_f32_dpp v53, v53, v53 row_ror:12 row_mask:0xf bank_mask:0x5
    v_add_f32_dpp v54, v54, v54 row_ror:12 row_mask:0xf bank_mask:0x5
    v_add_f32_dpp v55, v55, v55 row_ror:12 row_mask:0xf bank_mask:0x5
    v_add_f32_dpp v52, v56, v56 row_ror:4 row_mask:0xf bank_mask:0xa
    v_add_f32_dpp v53, v57, v57 row_ror:4 row_mask:0xf bank_mask:0xa
    v_add_f32_dpp v54, v58, v58 row_ror:4 row_mask:0xf bank_mask:0xa
    v_add_f32_dpp v55, v59, v59 row_ror:4 row_mask:0xf bank_mask:0xa
    v_add_f32_dpp v60, v52, v52 quad_perm:[2,3,0,1] row_mask:0xf bank_mask:0xf
    v_add_f32_dpp v61, v53, v53 quad_perm:[2,3,0,1] row_mask:0xf bank_mask:0xf
    v_add_f32_dpp v62, v54, v54 quad_perm:[2,3,0,1] row_mask:0xf bank_mask:0xf
    v_add_f32_dpp v63, v55, v55 quad_perm:[2,3,0,1] row_mask:0xf bank_mask:0xf
    v_cndmask_b32_e64 v52, v60, v62, s[96:97]
    v_cndmask_b32_e64 v53, v61, v63, s[96:97]
    s_nop 0
    v_add_f32_dpp v60, v52, v52 quad_perm:[1,0,3,2] row_mask:0xf bank_mask:0xf
    v_add_f32_dpp v61, v53, v53 quad_perm:[1,0,3,2] row_mask:0xf bank_mask:0xf
    v_cndmask_b32_e64 v14, v60, v61, s[94:95]
    v_cvt_pk_bf16_f32 v14, v14, v14
    v_and_b32 v14, 0xffff0000, v14
    v_mul_f32 v14, 0x3db504f3, v14
    v_cvt_pk_bf16_f32 v14, v14, v14
    v_and_b32 v14, 0xffff0000, v14
    v_mov_b32 v15, v14
    s_nop 1
    v_max_f32_dpp v15, v15, v15 row_ror:8 row_mask:0xf bank_mask:0xf
    s_nop 1
    v_max_f32_dpp v15, v15, v15 row_ror:4 row_mask:0xf bank_mask:0xf
    s_nop 1
    v_max_f32_dpp v15, v15, v15 row_ror:2 row_mask:0xf bank_mask:0xf
    s_nop 1
    v_max_f32_dpp v15, v15, v15 row_ror:1 row_mask:0xf bank_mask:0xf
    v_mov_b32 v16, v15
    s_nop 1
    v_permlane16_swap_b32 v15, v16
    s_nop 0
    v_max_f32 v15, v15, v16
    v_mov_b32 v16, v15
    s_nop 1
    v_permlane32_swap_b32 v15, v16
    s_nop 0
    v_max_f32 v15, v15, v16
    v_max_f32 v15, v15, v11
    v_sub_f32 v16, v11, v15
    v_sub_f32 v14, v14, v15
    v_mul_f32 v16, 0x3fb8aa3b, v16
    v_mul_f32 v14, 0x3fb8aa3b, v14
    v_exp_f32 v16, v16
    v_exp_f32 v14, v14
    v_mov_b32 v11, v15
    v_cvt_pk_bf16_f32 v13, v14, v14
    v_fma_f32 v12, v12, v16, v14
    v_mul_f32 v40, v16, v40
    v_mul_f32 v41, v16, v41
    v_mul_f32 v42, v16, v42
    v_mul_f32 v43, v16, v43
    v_and_b32_dpp v44, v13, v32 row_newbcast:0 row_mask:0xf bank_mask:0xf
    v_and_b32_dpp v45, v13, v33 row_newbcast:0 row_mask:0xf bank_mask:0xf
    v_and_b32_dpp v46, v13, v34 row_newbcast:0 row_mask:0xf bank_mask:0xf
    v_and_b32_dpp v47, v13, v35 row_newbcast:0 row_mask:0xf bank_mask:0xf
    s_waitcnt vmcnt(2)
    buffer_load_dwordx4 v[80:83], v2, s[16:19], s55 offen offset:3072 nt
    v_and_b32_dpp v48, v13, v32 row_newbcast:1 row_mask:0xf bank_mask:0xf
    v_and_b32_dpp v49, v13, v33 row_newbcast:1 row_mask:0xf bank_mask:0xf
    v_and_b32_dpp v50, v13, v34 row_newbcast:1 row_mask:0xf bank_mask:0xf
    v_and_b32_dpp v51, v13, v35 row_newbcast:1 row_mask:0xf bank_mask:0xf
    v_mfma_f32_16x16x32_bf16 v[40:43], v[68:71], v[44:47], v[40:43]
    s_waitcnt vmcnt(2)
    s_add_u32 s55, s55, 32768
    buffer_load_dwordx4 v[84:87], v2, s[16:19], s55 offen offset:0 nt
    v_and_b32_dpp v44, v13, v32 row_newbcast:2 row_mask:0xf bank_mask:0xf
    v_and_b32_dpp v45, v13, v33 row_newbcast:2 row_mask:0xf bank_mask:0xf
    v_and_b32_dpp v46, v13, v34 row_newbcast:2 row_mask:0xf bank_mask:0xf
    v_and_b32_dpp v47, v13, v35 row_newbcast:2 row_mask:0xf bank_mask:0xf
    v_mfma_f32_16x16x32_bf16 v[40:43], v[72:75], v[48:51], v[40:43]
    s_waitcnt vmcnt(2)
    buffer_load_dwordx4 v[88:91], v2, s[16:19], s55 offen offset:1024 nt
    v_and_b32_dpp v48, v13, v32 row_newbcast:3 row_mask:0xf bank_mask:0xf
    v_and_b32_dpp v49, v13, v33 row_newbcast:3 row_mask:0xf bank_mask:0xf
    v_and_b32_dpp v50, v13, v34 row_newbcast:3 row_mask:0xf bank_mask:0xf
    v_and_b32_dpp v51, v13, v35 row_newbcast:3 row_mask:0xf bank_mask:0xf
    v_mfma_f32_16x16x32_bf16 v[40:43], v[76:79], v[44:47], v[40:43]
    s_waitcnt vmcnt(2)
    buffer_load_dwordx4 v[92:95], v2, s[16:19], s55 offen offset:2048 nt
    v_and_b32_dpp v44, v13, v32 row_newbcast:4 row_mask:0xf bank_mask:0xf
    v_and_b32_dpp v45, v13, v33 row_newbcast:4 row_mask:0xf bank_mask:0xf
    v_and_b32_dpp v46, v13, v34 row_newbcast:4 row_mask:0xf bank_mask:0xf
    v_and_b32_dpp v47, v13, v35 row_newbcast:4 row_mask:0xf bank_mask:0xf
    v_mfma_f32_16x16x32_bf16 v[40:43], v[80:83], v[48:51], v[40:43]
    s_waitcnt vmcnt(2)
    buffer_load_dwordx4 v[96:99], v2, s[16:19], s55 offen offset:3072 nt
    v_and_b32_dpp v48, v13, v32 row_newbcast:5 row_mask:0xf bank_mask:0xf
    v_and_b32_dpp v49, v13, v33 row_newbcast:5 row_mask:0xf bank_mask:0xf
    v_and_b32_dpp v50, v13, v34 row_newbcast:5 row_mask:0xf bank_mask:0xf
    v_and_b32_dpp v51, v13, v35 row_newbcast:5 row_mask:0xf bank_mask:0xf
    v_mfma_f32_16x16x32_bf16 v[40:43], v[84:87], v[44:47], v[40:43]
    s_branch L_DEC
L_LAST:
    s_waitcnt vmcnt(2)
    s_add_u32 s55, s55, 32768
    buffer_load_dwordx4 v[100:103], v2, s[16:19], s55 offen offset:0 nt
    v_lshlrev_b32 v237, 4, v1
    v_mov_b32 v248, 1
    s_mov_b64 exec, 1
    buffer_atomic_add v248, off, s[44:47], s77 sc0
    s_mov_b64 exec, -1
    v_and_b32_dpp v44, v13, v32 row_newbcast:6 row_mask:0xf bank_mask:0xf
    v_and_b32_dpp v45, v13, v33 row_newbcast:6 row_mask:0xf bank_mask:0xf
    v_and_b32_dpp v46, v13, v34 row_newbcast:6 row_mask:0xf bank_mask:0xf
    v_and_b32_dpp v47, v13, v35 row_newbcast:6 row_mask:0xf bank_mask:0xf
    v_mfma_f32_16x16x32_bf16 v[40:43], v[88:91], v[48:51], v[40:43]
    s_waitcnt vmcnt(3)
    buffer_load_dwordx4 v[104:107], v2, s[16:19], s55 offen offset:1024 nt
    v_and_b32_dpp v48, v13, v32 row_newbcast:7 row_mask:0xf bank_mask:0xf
    v_and_b32_dpp v49, v13, v33 row_newbcast:7 row_mask:0xf bank_mask:0xf
    v_and_b32_dpp v50, v13, v34 row_newbcast:7 row_mask:0xf bank_mask:0xf
    v_and_b32_dpp v51, v13, v35 row_newbcast:7 row_mask:0xf bank_mask:0xf
    v_mfma_f32_16x16x32_bf16 v[40:43], v[92:95], v[44:47], v[40:43]
    s_waitcnt vmcnt(3)
    buffer_load_dwordx4 v[108:111], v2, s[16:19], s55 offen offset:2048 nt
    v_and_b32_dpp v44, v13, v32 row_newbcast:8 row_mask:0xf bank_mask:0xf
    v_and_b32_dpp v45, v13, v33 row_newbcast:8 row_mask:0xf bank_mask:0xf
    v_and_b32_dpp v46, v13, v34 row_newbcast:8 row_mask:0xf bank_mask:0xf
    v_and_b32_dpp v47, v13, v35 row_newbcast:8 row_mask:0xf bank_mask:0xf
    v_mfma_f32_16x16x32_bf16 v[40:43], v[96:99], v[48:51], v[40:43]
    s_waitcnt vmcnt(3)
    buffer_load_dwordx4 v[112:115], v2, s[16:19], s55 offen offset:3072 nt
    v_and_b32_dpp v48, v13, v32 row_newbcast:9 row_mask:0xf bank_mask:0xf
    v_and_b32_dpp v49, v13, v33 row_newbcast:9 row_mask:0xf bank_mask:0xf
    v_and_b32_dpp v50, v13, v34 row_newbcast:9 row_mask:0xf bank_mask:0xf
    v_and_b32_dpp v51, v13, v35 row_newbcast:9 row_mask:0xf bank_mask:0xf
    v_mfma_f32_16x16x32_bf16 v[40:43], v[100:103], v[44:47], v[40:43]
    s_waitcnt vmcnt(2)
    s_add_u32 s55, s55, 32768
    buffer_load_dwordx4 v[116:119], v2, s[16:19], s55 offen offset:0 nt
    v_and_b32_dpp v44, v13, v32 row_newbcast:10 row_mask:0xf bank_mask:0xf
    v_and_b32_dpp v45, v13, v33 row_newbcast:10 row_mask:0xf bank_mask:0xf
    v_and_b32_dpp v46, v13, v34 row_newbcast:10 row_mask:0xf bank_mask:0xf
    v_and_b32_dpp v47, v13, v35 row_newbcast:10 row_mask:0xf bank_mask:0xf
    v_mfma_f32_16x16x32_bf16 v[40:43], v[104:107], v[48:51], v[40:43]
    s_waitcnt vmcnt(2)
    buffer_load_dwordx4 v[120:123], v2, s[16:19], s55 offen offset:1024 nt
    v_readfirstlane_b32 s57, v248
    s_nop 0
    s_mul_i32 s59, s57, 43691
    s_lshr_b32 s59, s59, 17
    s_mul_i32 s58, s59, 3
    s_sub_u32 s58, s57, s58
    s_add_u32 s58, s58, 1
    s_lshl_b32 s58, s58, 20
    s_lshl_b32 s59, s59, 11
    s_add_u32 s58, s58, s59
    s_add_u32 s58, s58, s76
    s_add_u32 s58, s58, 917504
    s_cmp_lt_u32 s57, 192
    s_cselect_b32 s78, s58, 0xf0000000
    v_mov_b32 v248, 1
    s_mov_b64 exec, 1
    buffer_atomic_add v248, off, s[44:47], s77 sc0
    s_mov_b64 exec, -1
    v_and_b32_dpp v48, v13, v32 row_newbcast:11 row_mask:0xf bank_mask:0xf
    v_and_b32_dpp v49, v13, v33 row_newbcast:11 row_mask:0xf bank_mask:0xf
    v_and_b32_dpp v50, v13, v34 row_newbcast:11 row_mask:0xf bank_mask:0xf
    v_and_b32_dpp v51, v13, v35 row_newbcast:11 row_mask:0xf bank_mask:0xf
    v_mfma_f32_16x16x32_bf16 v[40:43], v[108:111], v[44:47], v[40:43]
    s_waitcnt vmcnt(3)
    buffer_load_dwordx4 v[124:127], v2, s[16:19], s55 offen offset:2048 nt
    v_and_b32_dpp v44, v13, v32 row_newbcast:12 row_mask:0xf bank_mask:0xf
    v_and_b32_dpp v45, v13, v33 row_newbcast:12 row_mask:0xf bank_mask:0xf
    v_and_b32_dpp v46, v13, v34 row_newbcast:12 row_mask:0xf bank_mask:0xf
    v_and_b32_dpp v47, v13, v35 row_newbcast:12 row_mask:0xf bank_mask:0xf
    v_mfma_f32_16x16x32_bf16 v[40:43], v[112:115], v[48:51], v[40:43]
    s_waitcnt vmcnt(3)
    buffer_load_dwordx4 v[128:131], v2, s[16:19], s55 offen offset:3072 nt
    buffer_load_dwordx4 v[68:71], v237, s[12:15], s78 offen offset:0 nt
    v_and_b32_dpp v48, v13, v32 row_newbcast:13 row_mask:0xf bank_mask:0xf
    v_and_b32_dpp v49, v13, v33 row_newbcast:13 row_mask:0xf bank_mask:0xf
    v_and_b32_dpp v50, v13, v34 row_newbcast:13 row_mask:0xf bank_mask:0xf
    v_and_b32_dpp v51, v13, v35 row_newbcast:13 row_mask:0xf bank_mask:0xf
    v_mfma_f32_16x16x32_bf16 v[40:43], v[116:119], v[44:47], v[40:43]
    s_waitcnt vmcnt(4)
    buffer_load_dwordx4 v[72:75], v237, s[12:15], s78 offen offset:1024 nt
    v_and_b32_dpp v44, v13, v32 row_newbcast:14 row_mask:0xf bank_mask:0xf
    v_and_b32_dpp v45, v13, v33 row_newbcast:14 row_mask:0xf bank_mask:0xf
    v_and_b32_dpp v46, v13, v34 row_newbcast:14 row_mask:0xf bank_mask:0xf
    v_and_b32_dpp v47, v13, v35 row_newbcast:14 row_mask:0xf bank_mask:0xf
    v_mfma_f32_16x16x32_bf16 v[40:43], v[120:123], v[48:51], v[40:43]
    s_waitcnt vmcnt(3)
    buffer_load_dwordx4 v[76:79], v237, s[16:19], s78 offen offset:0 nt
    v_and_b32_dpp v48, v13, v32 row_newbcast:15 row_mask:0xf bank_mask:0xf
    v_and_b32_dpp v49, v13, v33 row_newbcast:15 row_mask:0xf bank_mask:0xf
    v_and_b32_dpp v50, v13, v34 row_newbcast:15 row_mask:0xf bank_mask:0xf
    v_and_b32_dpp v51, v13, v35 row_newbcast:15 row_mask:0xf bank_mask:0xf
    v_mfma_f32_16x16x32_bf16 v[40:43], v[124:127], v[44:47], v[40:43]
    s_waitcnt vmcnt(3)
    v_readfirstlane_b32 s57, v248
    s_nop 0
    s_mul_i32 s59, s57, 43691
    s_lshr_b32 s59, s59, 17
    s_mul_i32 s58, s59, 3
    s_sub_u32 s58, s57, s58
    s_add_u32 s58, s58, 1
    s_lshl_b32 s58, s58, 20
    s_lshl_b32 s59, s59, 11
    s_add_u32 s58, s58, s59
    s_add_u32 s58, s58, s76
    s_add_u32 s58, s58, 917504
    s_cmp_lt_u32 s57, 192
    s_cselect_b32 s79, s58, 0xf0000000
    v_mov_b32 v249, 1
    s_mov_b64 exec, 1
    buffer_atomic_add v249, off, s[44:47], s77 sc0
    s_mov_b64 exec, -1
    buffer_load_dwordx4 v[80:83], v237, s[16:19], s78 offen offset:1024 nt
    s_nop 1
    v_mfma_f32_16x16x32_bf16 v[40:43], v[128:131], v[48:51], v[40:43]
    s_cmp_ge_u32 s78, 0xf0000000
    s_cbranch_scc1 L_dend_36
L_DYN:
    s_waitcnt vmcnt(3)
    v_mov_b32 v248, 1
    s_mov_b64 exec, 1
    buffer_atomic_add v248, off, s[44:47], s77 sc0
    s_mov_b64 exec, -1
    buffer_load_dwordx4 v[84:87], v237, s[12:15], s79 offen offset:0 nt
    v_dot2_f32_bf16 v52, v68, v36, 0
    v_dot2_f32_bf16 v52, v69, v37, v52
    v_dot2_f32_bf16 v52, v70, v38, v52
    v_dot2_f32_bf16 v52, v71, v39, v52
    s_waitcnt vmcnt(4)
    buffer_load_dwordx4 v[88:91], v237, s[12:15], s79 offen offset:1024 nt
    v_dot2_f32_bf16 v53, v72, v36, 0
    v_dot2_f32_bf16 v53, v73, v37, v53
    v_dot2_f32_bf16 v53, v74, v38, v53
    v_dot2_f32_bf16 v53, v75, v39, v53
    s_nop 2
    v_add_f32_dpp v52, v52, v52 row_ror:8 row_mask:0xf bank_mask:0x3
    s_nop 1
    v_add_f32_dpp v52, v53, v53 row_ror:8 row_mask:0xf bank_mask:0xc
    s_nop 1
    v_add_f32_dpp v52, v52, v52 quad_perm:[2,3,0,1] row_mask:0xf bank_mask:0xf
    s_nop 1
    v_add_f32_dpp v52, v52, v52 quad_perm:[1,0,3,2] row_mask:0xf bank_mask:0xf
    s_nop 1
    v_add_f32_dpp v14, v52, v52 row_half_mirror row_mask:0xf bank_mask:0xf
    v_cvt_pk_bf16_f32 v14, v14, v14
    v_and_b32 v14, 0xffff0000, v14
    v_mul_f32 v14, 0x3db504f3, v14
    v_cvt_pk_bf16_f32 v14, v14, v14
    v_and_b32 v14, 0xffff0000, v14
    s_nop 1
    v_max_f32_dpp v15, v14, v14 row_ror:8 row_mask:0xf bank_mask:0xf
    v_mov_b32 v16, v15
    s_nop 1
    v_permlane16_swap_b32 v15, v16
    s_nop 0
    v_max_f32 v15, v15, v16
    v_mov_b32 v16, v15
    s_nop 1
    v_permlane32_swap_b32 v15, v16
    s_nop 0
    v_max_f32 v15, v15, v16
    v_max_f32 v15, v15, v11
    v_sub_f32 v16, v11, v15
    v_sub_f32 v14, v14, v15
    v_mul_f32 v16, 0x3fb8aa3b, v16
    v_mul_f32 v14, 0x3fb8aa3b, v14
    v_exp_f32 v16, v16
    v_exp_f32 v14, v14
    v_mov_b32 v11, v15
    v_cvt_pk_bf16_f32 v13, v14, v14
    v_mul_f32 v14, 0x3e000000, v14
    v_mul_f32 v40, v16, v40
    v_mul_f32 v41, v16, v41
    v_mul_f32 v42, v16, v42
    v_mul_f32 v43, v16, v43
    v_fma_f32 v12, v12, v16, v14
    v_and_b32_dpp v44, v13, v32 row_newbcast:0 row_mask:0xf bank_mask:0xf
    v_and_b32_dpp v45, v13, v33 row_newbcast:0 row_mask:0xf bank_mask:0xf
    v_and_b32_dpp v46, v13, v34 row_newbcast:0 row_mask:0xf bank_mask:0xf
    v_and_b32_dpp v47, v13, v35 row_newbcast:0 row_mask:0xf bank_mask:0xf
    s_waitcnt vmcnt(4)
    buffer_load_dwordx4 v[92:95], v237, s[16:19], s79 offen offset:0 nt
    v_and_b32_dpp v48, v13, v32 row_newbcast:8 row_mask:0xf bank_mask:0xf
    v_and_b32_dpp v49, v13, v33 row_newbcast:8 row_mask:0xf bank_mask:0xf
    v_and_b32_dpp v50, v13, v34 row_newbcast:8 row_mask:0xf bank_mask:0xf
    v_and_b32_dpp v51, v13, v35 row_newbcast:8 row_mask:0xf bank_mask:0xf
    v_mfma_f32_16x16x32_bf16 v[40:43], v[76:79], v[44:47], v[40:43]
    s_waitcnt vmcnt(4)
    buffer_load_dwordx4 v[96:99], v237, s[16:19], s79 offen offset:1024 nt
    v_readfirstlane_b32 s57, v249
    s_nop 0
    s_mul_i32 s59, s57, 43691
    s_lshr_b32 s59, s59, 17
    s_mul_i32 s58, s59, 3
    s_sub_u32 s58, s57, s58
    s_add_u32 s58, s58, 1
    s_lshl_b32 s58, s58, 20
    s_lshl_b32 s59, s59, 11
    s_add_u32 s58, s58, s59
    s_add_u32 s58, s58, s76
    s_add_u32 s58, s58, 917504
    s_cmp_lt_u32 s57, 192
    s_cselect_b32 s80, s58, 0xf0000000
    s_nop 1
    v_mfma_f32_16x16x32_bf16 v[40:43], v[80:83], v[48:51], v[40:43]
    s_mov_b32 s78, s79
    s_mov_b32 s79, s80
    s_cmp_ge_u32 s78, 0xf0000000
    s_cbranch_scc1 L_dend_36
    s_waitcnt vmcnt(3)
    v_mov_b32 v249, 1
    s_mov_b64 exec, 1
    buffer_atomic_add v249, off, s[44:47], s77 sc0
    s_mov_b64 exec, -1
    buffer_load_dwordx4 v[68:71], v237, s[12:15], s79 offen offset:0 nt
    v_dot2_f32_bf16 v52, v84, v36, 0
    v_dot2_f32_bf16 v52, v85, v37, v52
    v_dot2_f32_bf16 v52, v86, v38, v52
    v_dot2_f32_bf16 v52, v87, v39, v52
    s_waitcnt vmcnt(4)
    buffer_load_dwordx4 v[72:75], v237, s[12:15], s79 offen offset:1024 nt
    v_dot2_f32_bf16 v53, v88, v36, 0
    v_dot2_f32_bf16 v53, v89, v37, v53
    v_dot2_f32_bf16 v53, v90, v38, v53
    v_dot2_f32_bf16 v53, v91, v39, v53
    s_nop 2
    v_add_f32_dpp v52, v52, v52 row_ror:8 row_mask:0xf bank_mask:0x3
    s_nop 1
    v_add_f32_dpp v52, v53, v53 row_ror:8 row_mask:0xf bank_mask:0xc
    s_nop 1
    v_add_f32_dpp v52, v52, v52 quad_perm:[2,3,0,1] row_mask:0xf bank_mask:0xf
    s_nop 1
    v_add_f32_dpp v52, v52, v52 quad_perm:[1,0,3,2] row_mask:0xf bank_mask:0xf
    s_nop 1
    v_add_f32_dpp v14, v52, v52 row_half_mirror row_mask:0xf bank_mask:0xf
    v_cvt_pk_bf16_f32 v14, v14, v14
    v_and_b32 v14, 0xffff0000, v14
    v_mul_f32 v14, 0x3db504f3, v14
    v_cvt_pk_bf16_f32 v14, v14, v14
    v_and_b32 v14, 0xffff0000, v14
    s_nop 1
    v_max_f32_dpp v15, v14, v14 row_ror:8 row_mask:0xf bank_mask:0xf
    v_mov_b32 v16, v15
    s_nop 1
    v_permlane16_swap_b32 v15, v16
    s_nop 0
    v_max_f32 v15, v15, v16
    v_mov_b32 v16, v15
    s_nop 1
    v_permlane32_swap_b32 v15, v16
    s_nop 0
    v_max_f32 v15, v15, v16
    v_max_f32 v15, v15, v11
    v_sub_f32 v16, v11, v15
    v_sub_f32 v14, v14, v15
    v_mul_f32 v16, 0x3fb8aa3b, v16
    v_mul_f32 v14, 0x3fb8aa3b, v14
    v_exp_f32 v16, v16
    v_exp_f32 v14, v14
    v_mov_b32 v11, v15
    v_cvt_pk_bf16_f32 v13, v14, v14
    v_mul_f32 v14, 0x3e000000, v14
    v_mul_f32 v40, v16, v40
    v_mul_f32 v41, v16, v41
    v_mul_f32 v42, v16, v42
    v_mul_f32 v43, v16, v43
    v_fma_f32 v12, v12, v16, v14
    v_and_b32_dpp v44, v13, v32 row_newbcast:0 row_mask:0xf bank_mask:0xf
    v_and_b32_dpp v45, v13, v33 row_newbcast:0 row_mask:0xf bank_mask:0xf
    v_and_b32_dpp v46, v13, v34 row_newbcast:0 row_mask:0xf bank_mask:0xf
    v_and_b32_dpp v47, v13, v35 row_newbcast:0 row_mask:0xf bank_mask:0xf
    s_waitcnt vmcnt(4)
    buffer_load_dwordx4 v[76:79], v237, s[16:19], s79 offen offset:0 nt
    v_and_b32_dpp v48, v13, v32 row_newbcast:8 row_mask:0xf bank_mask:0xf
    v_and_b32_dpp v49, v13, v33 row_newbcast:8 row_mask:0xf bank_mask:0xf
    v_and_b32_dpp v50, v13, v34 row_newbcast:8 row_mask:0xf bank_mask:0xf
    v_and_b32_dpp v51, v13, v35 row_newbcast:8 row_mask:0xf bank_mask:0xf
    v_mfma_f32_16x16x32_bf16 v[40:43], v[92:95], v[44:47], v[40:43]
    s_waitcnt vmcnt(4)
    buffer_load_dwordx4 v[80:83], v237, s[16:19], s79 offen offset:1024 nt
    v_readfirstlane_b32 s57, v248
    s_nop 0
    s_mul_i32 s59, s57, 43691
    s_lshr_b32 s59, s59, 17
    s_mul_i32 s58, s59, 3
    s_sub_u32 s58, s57, s58
    s_add_u32 s58, s58, 1
    s_lshl_b32 s58, s58, 20
    s_lshl_b32 s59, s59, 11
    s_add_u32 s58, s58, s59
    s_add_u32 s58, s58, s76
    s_add_u32 s58, s58, 917504
    s_cmp_lt_u32 s57, 192
    s_cselect_b32 s80, s58, 0xf0000000
    s_nop 1
    v_mfma_f32_16x16x32_bf16 v[40:43], v[96:99], v[48:51], v[40:43]
    s_mov_b32 s78, s79
    s_mov_b32 s79, s80
    s_cmp_lt_u32 s78, 0xf0000000
    s_cbranch_scc1 L_DYN
L_dend_36:
    s_nop 1
    v_add_f32_dpp v12, v12, v12 row_ror:8 row_mask:0xf bank_mask:0xf
    s_nop 1
    v_add_f32_dpp v12, v12, v12 row_ror:4 row_mask:0xf bank_mask:0xf
    s_nop 1
    v_add_f32_dpp v12, v12, v12 row_ror:2 row_mask:0xf bank_mask:0xf
    s_nop 1
    v_add_f32_dpp v12, v12, v12 row_ror:1 row_mask:0xf bank_mask:0xf
    v_mov_b32 v14, v12
    s_nop 1
    v_permlane16_swap_b32 v12, v14
    s_nop 0
    v_add_f32 v12, v12, v14
    v_mov_b32 v14, v12
    s_nop 1
    v_permlane32_swap_b32 v12, v14
    s_nop 0
    v_add_f32 v12, v12, v14
    s_nop 3
    ds_write_b128 v7, v[40:43] offset:4096
    s_lshl_b32 s57, s3, 3
    v_mov_b32 v14, s57
    v_mov_b32 v16, v11
    v_mov_b32 v17, v12
    ds_write_b64 v14, v[16:17] offset:3392
    s_waitcnt lgkmcnt(0)
    s_barrier
    s_cmp_lg_u32 s3, 0
    s_cbranch_scc1 L_t1skip_37
    v_and_b32 v14, 7, v1
    v_lshlrev_b32 v14, 3, v14
    ds_read_b64 v[16:17], v14 offset:3392
    v_add_u32 v18, 4096, v8
    v_add_u32 v19, 16, v18
    ds_read2st64_b32 v[212:213], v18 offset0:0 offset1:4
    ds_read2st64_b32 v[214:215], v18 offset0:8 offset1:12
    ds_read2st64_b32 v[216:217], v18 offset0:16 offset1:20
    ds_read2st64_b32 v[218:219], v18 offset0:24 offset1:28
    ds_read2st64_b32 v[220:221], v19 offset0:0 offset1:4
    ds_read2st64_b32 v[222:223], v19 offset0:8 offset1:12
    ds_read2st64_b32 v[224:225], v19 offset0:16 offset1:20
    ds_read2st64_b32 v[226:227], v19 offset0:24 offset1:28
    v_lshlrev_b32 v21, 4, v1
    v_add_u32 v21, 6144, v21
    v_mov_b32 v22, 7168
    s_waitcnt lgkmcnt(8)
    v_max_f32_dpp v20, v16, v16 row_ror:4 row_mask:0xf bank_mask:0xf
    s_nop 1
    v_max_f32_dpp v20, v20, v20 row_ror:2 row_mask:0xf bank_mask:0xf
    s_nop 1
    v_max_f32_dpp v20, v20, v20 row_ror:1 row_mask:0xf bank_mask:0xf
    v_sub_f32 v16, v16, v20
    v_mul_f32 v16, 0x3fb8aa3b, v16
    v_exp_f32 v16, v16
    s_nop 0
    v_mul_f32 v23, v16, v17
    s_waitcnt lgkmcnt(0)
    v_mul_f32_dpp v228, v16, v212 row_newbcast:0 row_mask:0xf bank_mask:0xf
    v_mul_f32_dpp v229, v16, v220 row_newbcast:0 row_mask:0xf bank_mask:0xf
    v_add_f32_dpp v23, v23, v23 row_ror:4 row_mask:0xf bank_mask:0xf
    v_fmac_f32_dpp v228, v16, v213 row_newbcast:1 row_mask:0xf bank_mask:0xf
    v_fmac_f32_dpp v229, v16, v221 row_newbcast:1 row_mask:0xf bank_mask:0xf
    s_nop 0
    v_fmac_f32_dpp v228, v16, v214 row_newbcast:2 row_mask:0xf bank_mask:0xf
    v_fmac_f32_dpp v229, v16, v222 row_newbcast:2 row_mask:0xf bank_mask:0xf
    v_add_f32_dpp v23, v23, v23 row_ror:2 row_mask:0xf bank_mask:0xf
    v_fmac_f32_dpp v228, v16, v215 row_newbcast:3 row_mask:0xf bank_mask:0xf
    v_fmac_f32_dpp v229, v16, v223 row_newbcast:3 row_mask:0xf bank_mask:0xf
    s_nop 0
    v_fmac_f32_dpp v228, v16, v216 row_newbcast:4 row_mask:0xf bank_mask:0xf
    v_fmac_f32_dpp v229, v16, v224 row_newbcast:4 row_mask:0xf bank_mask:0xf
    s_nop 0
    v_fmac_f32_dpp v228, v16, v217 row_newbcast:5 row_mask:0xf bank_mask:0xf
    v_fmac_f32_dpp v229, v16, v225 row_newbcast:5 row_mask:0xf bank_mask:0xf
    v_add_f32_dpp v23, v23, v23 row_ror:1 row_mask:0xf bank_mask:0xf
    v_fmac_f32_dpp v228, v16, v218 row_newbcast:6 row_mask:0xf bank_mask:0xf
    v_fmac_f32_dpp v229, v16, v226 row_newbcast:6 row_mask:0xf bank_mask:0xf
    s_nop 0
    v_fmac_f32_dpp v228, v16, v219 row_newbcast:7 row_mask:0xf bank_mask:0xf
    v_fmac_f32_dpp v229, v16, v227 row_newbcast:7 row_mask:0xf bank_mask:0xf
    s_nop 0
    v_mov_b32 v230, v229
    v_mov_b32 v229, v244
    v_mov_b32 v231, v245
    buffer_store_dwordx4 v[228:231], v21, s[44:47], s64 offen sc0 sc1
    v_mov_b32 v232, v20
    v_mov_b32 v233, v23
    s_mov_b64 exec, 1
    v_mov_b32 v234, v233
    v_mov_b32 v233, v244
    v_mov_b32 v235, v245
    buffer_store_dwordx4 v[232:235], v22, s[44:47], s64 offen sc0 sc1
    s_mov_b64 exec, -1
L_t1skip_37:
    s_barrier
    buffer_load_dwordx4 v[132:135], v5, s[32:35], s67 offen nt
    s_add_u32 s63, s67, 8192
    buffer_load_dwordx4 v[136:139], v5, s[32:35], s63 offen nt
    s_add_u32 s63, s67, 16384
    buffer_load_dwordx4 v[140:143], v5, s[32:35], s63 offen nt
    s_add_u32 s63, s67, 24576
    buffer_load_dwordx4 v[144:147], v5, s[32:35], s63 offen nt
    s_sub_u32 s59, s3, 2
    s_cmp_ge_u32 s59, 2
    s_cbranch_scc1 L_nodf_38
    s_cmp_ge_u32 s4, 28
    s_cbranch_scc1 L_nodf_38
    s_mov_b32 s57, 12288
    s_lshl_b32 s58, s59, 10
    s_add_u32 s58, s58, 10240
    v_add_u32 v14, s57, v8
    v_add_u32 v240, 16, v14
    ds_read2st64_b32 v[224:225], v14 offset0:0 offset1:4
    ds_read2st64_b32 v[226:227], v14 offset0:8 offset1:12
    ds_read2st64_b32 v[228:229], v14 offset0:16 offset1:20
    ds_read2st64_b32 v[230:231], v14 offset0:24 offset1:28
    ds_read2st64_b32 v[232:233], v240 offset0:0 offset1:4
    ds_read2st64_b32 v[234:235], v240 offset0:8 offset1:12
    ds_read2st64_b32 v[236:237], v240 offset0:16 offset1:20
    ds_read2st64_b32 v[238:239], v240 offset0:24 offset1:28
    s_waitcnt lgkmcnt(0)
    v_add_f32 v224, v224, v225
    v_add_f32 v226, v226, v227
    v_add_f32 v228, v228, v229
    v_add_f32 v230, v230, v231
    v_add_f32 v224, v224, v226
    v_add_f32 v228, v228, v230
    v_add_f32 v220, v224, v228
    v_add_f32 v232, v232, v233
    v_add_f32 v234, v234, v235
    v_add_f32 v236, v236, v237
    v_add_f32 v238, v238, v239
    v_add_f32 v232, v232, v234
    v_add_f32 v236, v236, v238
    v_add_f32 v221, v232, v236
    v_lshlrev_b32 v15, 4, v1
    v_add_u32 v15, s58, v15
    v_mov_b32 v222, v221
    v_mov_b32 v221, v244
    v_mov_b32 v223, v245
    buffer_store_dwordx4 v[220:223], v15, s[44:47], s64 offen sc0 sc1
L_nodf_38:
    s_cmp_ge_u32 s3, 2
    s_cbranch_scc1 L_t2skip_39
    v_lshlrev_b32 v21, 4, v1
    v_add_u32 v21, 6144, v21
    s_xor_b32 s70, s3, 0
    s_mul_i32 s70, s70, 16896
    s_add_u32 s70, s70, s65
    s_xor_b32 s71, s3, 3
    s_mul_i32 s71, s71, 16896
    s_add_u32 s71, s71, s65
    s_xor_b32 s72, s3, 5
    s_mul_i32 s72, s72, 16896
    s_add_u32 s72, s72, s65
    s_xor_b32 s73, s3, 6
    s_mul_i32 s73, s73, 16896
    s_add_u32 s73, s73, s65
    v_and_b32 v22, 3, v1
    v_lshrrev_b32 v23, 1, v22
    v_xor_b32 v23, v23, v22
    v_and_b32 v23, 1, v23
    v_lshl_add_u32 v22, v22, 1, v23
    v_xor_b32 v22, s3, v22
    s_mov_b32 s57, 16896
    v_mul_lo_u32 v22, v22, s57
    v_add_u32 v22, 7168, v22
    s_mov_b64 s[76:77], -1
    s_mov_b64 s[78:79], -1
    s_mov_b64 s[80:81], -1
    s_mov_b64 s[82:83], -1
    s_mov_b64 s[84:85], -1
    s_mov_b32 s66, 200000
L_mtop_40:
    s_cmp_eq_u64 s[76:77], 0
    s_cbranch_scc1 L_msk_42
    s_mov_b64 exec, s[76:77]
    buffer_load_dwordx4 v[84:87], v22, s[44:47], s65 offen sc1
L_msk_42:
    s_cmp_eq_u64 s[78:79], 0
    s_cbranch_scc1 L_msk_43
    s_mov_b64 exec, s[78:79]
    buffer_load_dwordx4 v[68:71], v21, s[44:47], s70 offen sc1
L_msk_43:
    s_cmp_eq_u64 s[80:81], 0
    s_cbranch_scc1 L_msk_44
    s_mov_b64 exec, s[80:81]
    buffer_load_dwordx4 v[72:75], v21, s[44:47], s71 offen sc1
L_msk_44:
    s_cmp_eq_u64 s[82:83], 0
    s_cbranch_scc1 L_msk_45
    s_mov_b64 exec, s[82:83]
    buffer_load_dwordx4 v[76:79], v21, s[44:47], s72 offen sc1
L_msk_45:
    s_cmp_eq_u64 s[84:85], 0
    s_cbranch_scc1 L_msk_46
    s_mov_b64 exec, s[84:85]
    buffer_load_dwordx4 v[80:83], v21, s[44:47], s73 offen sc1
L_msk_46:
    s_mov_b64 exec, -1
    s_waitcnt vmcnt(0)
    v_cmp_ne_u32 vcc, v85, v244
    v_cmp_ne_u32_e64 s[98:99], v87, v245
    s_nop 0
    s_or_b64 s[98:99], s[98:99], vcc
    s_and_b64 s[76:77], s[76:77], s[98:99]
    v_cmp_ne_u32 vcc, v69, v244
    v_cmp_ne_u32_e64 s[98:99], v71, v245
    s_nop 0
    s_or_b64 s[98:99], s[98:99], vcc
    s_and_b64 s[78:79], s[78:79], s[98:99]
    v_cmp_ne_u32 vcc, v73, v244
    v_cmp_ne_u32_e64 s[98:99], v75, v245
    s_nop 0
    s_or_b64 s[98:99], s[98:99], vcc
    s_and_b64 s[80:81], s[80:81], s[98:99]
    v_cmp_ne_u32 vcc, v77, v244
    v_cmp_ne_u32_e64 s[98:99], v79, v245
    s_nop 0
    s_or_b64 s[98:99], s[98:99], vcc
    s_and_b64 s[82:83], s[82:83], s[98:99]
    v_cmp_ne_u32 vcc, v81, v244
    v_cmp_ne_u32_e64 s[98:99], v83, v245
    s_nop 0
    s_or_b64 s[98:99], s[98:99], vcc
    s_and_b64 s[84:85], s[84:85], s[98:99]
    s_or_b64 s[98:99], s[76:77], s[78:79]
    s_or_b64 s[98:99], s[98:99], s[80:81]
    s_or_b64 s[98:99], s[98:99], s[82:83]
    s_or_b64 s[98:99], s[98:99], s[84:85]
    s_cbranch_scc0 L_mdone_41
    s_sub_u32 s66, s66, 1
    s_cbranch_scc0 L_mtop_40
L_mdone_41:
    v_mov_b32 v212, v68
    v_mov_b32 v213, v70
    v_mov_b32 v214, v72
    v_mov_b32 v215, v74
    v_mov_b32 v216, v76
    v_mov_b32 v217, v78
    v_mov_b32 v218, v80
    v_mov_b32 v219, v82
    v_mov_b32 v220, v84
    v_mov_b32 v221, v86
    s_nop 0
    v_max_f32_dpp v14, v220, v220 quad_perm:[1,0,3,2] row_mask:0xf bank_mask:0xf
    s_nop 1
    v_max_f32_dpp v14, v14, v14 quad_perm:[2,3,0,1] row_mask:0xf bank_mask:0xf
    v_sub_f32 v15, v220, v14
    v_mul_f32 v15, 0x3fb8aa3b, v15
    v_exp_f32 v15, v15
    s_nop 0
    v_mul_f32 v16, v15, v221
    s_nop 0
    v_mul_f32_dpp v17, v15, v212 quad_perm:[0,0,0,0] row_mask:0xf bank_mask:0xf
    v_mul_f32_dpp v18, v15, v213 quad_perm:[0,0,0,0] row_mask:0xf bank_mask:0xf
    v_add_f32_dpp v16, v16, v16 quad_perm:[1,0,3,2] row_mask:0xf bank_mask:0xf
    v_fmac_f32_dpp v17, v15, v214 quad_perm:[1,1,1,1] row_mask:0xf bank_mask:0xf
    v_fmac_f32_dpp v18, v15, v215 quad_perm:[1,1,1,1] row_mask:0xf bank_mask:0xf
    v_add_f32_dpp v16, v16, v16 quad_perm:[2,3,0,1] row_mask:0xf bank_mask:0xf
    v_fmac_f32_dpp v17, v15, v216 quad_perm:[2,2,2,2] row_mask:0xf bank_mask:0xf
    v_fmac_f32_dpp v18, v15, v217 quad_perm:[2,2,2,2] row_mask:0xf bank_mask:0xf
    s_nop 0
    v_fmac_f32_dpp v17, v15, v218 quad_perm:[3,3,3,3] row_mask:0xf bank_mask:0xf
    v_fmac_f32_dpp v18, v15, v219 quad_perm:[3,3,3,3] row_mask:0xf bank_mask:0xf
    s_nop 0
    v_rcp_f32 v16, v16
    s_lshl_b32 s57, s3, 9
    s_add_u32 s57, s57, 2048
    v_add_u32 v19, s57, v9
    v_mul_f32 v17, v17, v16
    v_mul_f32 v18, v18, v16
    v_cvt_pk_bf16_f32 v17, v17, v17
    v_cvt_pk_bf16_f32 v18, v18, v18
    ds_write2_b32 v19, v17, v18 offset0:0 offset1:4
L_t2skip_39:
    s_waitcnt lgkmcnt(0)
    s_barrier
    s_waitcnt vmcnt(0)
    ds_read_b128 v[212:215], v6 offset:2048
    s_waitcnt lgkmcnt(0)
    v_and_b32 v44, v212, v32
    v_and_b32 v45, v212, v33
    v_and_b32 v46, v212, v34
    v_and_b32 v47, v212, v35
    v_and_b32 v48, v213, v32
    v_and_b32 v49, v213, v33
    v_and_b32 v50, v213, v34
    v_and_b32 v51, v213, v35
    v_mfma_f32_16x16x32_bf16 v[216:219], v[132:135], v[44:47], 0
    v_and_b32 v44, v214, v32
    v_and_b32 v45, v214, v33
    v_and_b32 v46, v214, v34
    v_and_b32 v47, v214, v35
    v_mfma_f32_16x16x32_bf16 v[216:219], v[136:139], v[48:51], v[216:219]
    v_and_b32 v48, v215, v32
    v_and_b32 v49, v215, v33
    v_and_b32 v50, v215, v34
    v_and_b32 v51, v215, v35
    v_mfma_f32_16x16x32_bf16 v[216:219], v[140:143], v[44:47], v[216:219]
    s_nop 1
    v_mfma_f32_16x16x32_bf16 v[216:219], v[144:147], v[48:51], v[216:219]
    s_nop 7
    ds_write_b128 v7, v[216:219] offset:20480
    s_waitcnt lgkmcnt(0)
    s_barrier
    s_cmp_ge_u32 s3, 3
    s_cbranch_scc1 L_EXIT
    s_cmp_eq_u32 s3, 2
    s_cbranch_scc1 L_t4_47
    s_mov_b32 s57, 20480
    s_lshl_b32 s58, s3, 10
    s_add_u32 s58, s58, 8192
    v_add_u32 v14, s57, v8
    v_add_u32 v240, 16, v14
    ds_read2st64_b32 v[224:225], v14 offset0:0 offset1:4
    ds_read2st64_b32 v[226:227], v14 offset0:8 offset1:12
    ds_read2st64_b32 v[228:229], v14 offset0:16 offset1:20
    ds_read2st64_b32 v[230:231], v14 offset0:24 offset1:28
    ds_read2st64_b32 v[232:233], v240 offset0:0 offset1:4
    ds_read2st64_b32 v[234:235], v240 offset0:8 offset1:12
    ds_read2st64_b32 v[236:237], v240 offset0:16 offset1:20
    ds_read2st64_b32 v[238:239], v240 offset0:24 offset1:28
    s_waitcnt lgkmcnt(0)
    v_add_f32 v224, v224, v225
    v_add_f32 v226, v226, v227
    v_add_f32 v228, v228, v229
    v_add_f32 v230, v230, v231
    v_add_f32 v224, v224, v226
    v_add_f32 v228, v228, v230
    v_add_f32 v220, v224, v228
    v_add_f32 v232, v232, v233
    v_add_f32 v234, v234, v235
    v_add_f32 v236, v236, v237
    v_add_f32 v238, v238, v239
    v_add_f32 v232, v232, v234
    v_add_f32 v236, v236, v238
    v_add_f32 v221, v232, v236
    v_lshlrev_b32 v15, 4, v1
    v_add_u32 v15, s58, v15
    v_mov_b32 v222, v221
    v_mov_b32 v221, v244
    v_mov_b32 v223, v245
    buffer_store_dwordx4 v[220:223], v15, s[44:47], s64 offen sc0 sc1
    s_branch L_EXIT
L_t4_47:
    v_lshrrev_b32 v18, 2, v1
    s_bfe_u32 s57, s2, 0x30004
    v_lshlrev_b32 v19, 3, v18
    v_add_u32 v19, s57, v19
    s_mov_b32 s58, 16896
    v_mul_lo_u32 v19, v19, s58
    s_lshr_b32 s57, s2, 7
    s_lshl_b32 s57, s57, 10
    s_and_b32 s58, s2, 15
    s_lshl_b32 s58, s58, 6
    s_add_u32 s57, s57, s58
    s_add_u32 s57, s57, 32768
    v_and_b32 v20, 3, v1
    v_lshlrev_b32 v20, 4, v20
    v_add_u32 v19, v19, v20
    v_add_u32 v19, s57, v19
    v_add_u32 v14, 8192, v19
    v_add_u32 v15, 2170880, v19
    v_add_u32 v16, 10240, v19
    v_add_u32 v17, 2172928, v19
    v_cmp_gt_u32 vcc, 12, v18
    v_mov_b32 v20, 0x7ff00000
    s_nop 0
    v_cndmask_b32 v17, v20, v17, vcc
    s_not_b64 s[74:75], vcc
    v_mov_b32 v68, 0
    v_mov_b32 v69, 0
    v_mov_b32 v70, 0
    v_mov_b32 v71, 0
    v_mov_b32 v72, 0
    v_mov_b32 v73, 0
    v_mov_b32 v74, 0
    v_mov_b32 v75, 0
    v_mov_b32 v76, 0
    v_mov_b32 v77, 0
    v_mov_b32 v78, 0
    v_mov_b32 v79, 0
    v_mov_b32 v80, 0
    v_mov_b32 v81, 0
    v_mov_b32 v82, 0
    v_mov_b32 v83, 0
    s_not_b64 s[72:73], s[74:75]
    s_mov_b64 s[76:77], -1
    s_mov_b64 s[78:79], -1
    s_mov_b64 s[80:81], -1
    s_mov_b64 s[82:83], s[72:73]
    s_mov_b32 s66, 200000
L_mtop_48:
    s_cmp_eq_u64 s[76:77], 0
    s_cbranch_scc1 L_msk_50
    s_mov_b64 exec, s[76:77]
    buffer_load_dwordx4 v[68:71], v14, s[44:47], 0 offen sc1
L_msk_50:
    s_cmp_eq_u64 s[78:79], 0
    s_cbranch_scc1 L_msk_51
    s_mov_b64 exec, s[78:79]
    buffer_load_dwordx4 v[72:75], v15, s[44:47], 0 offen sc1
L_msk_51:
    s_cmp_eq_u64 s[80:81], 0
    s_cbranch_scc1 L_msk_52
    s_mov_b64 exec, s[80:81]
    buffer_load_dwordx4 v[76:79], v16, s[44:47], 0 offen sc1
L_msk_52:
    s_cmp_eq_u64 s[82:83], 0
    s_cbranch_scc1 L_msk_53
    s_mov_b64 exec, s[82:83]
    buffer_load_dwordx4 v[80:83], v17, s[44:47], 0 offen sc1
L_msk_53:
    s_mov_b64 exec, -1
    s_waitcnt vmcnt(0)
    v_cmp_ne_u32 vcc, v69, v244
    v_cmp_ne_u32_e64 s[98:99], v71, v245
    s_nop 0
    s_or_b64 s[98:99], s[98:99], vcc
    s_and_b64 s[76:77], s[76:77], s[98:99]
    v_cmp_ne_u32 vcc, v73, v244
    v_cmp_ne_u32_e64 s[98:99], v75, v245
    s_nop 0
    s_or_b64 s[98:99], s[98:99], vcc
    s_and_b64 s[78:79], s[78:79], s[98:99]
    v_cmp_ne_u32 vcc, v77, v244
    v_cmp_ne_u32_e64 s[98:99], v79, v245
    s_nop 0
    s_or_b64 s[98:99], s[98:99], vcc
    s_and_b64 s[80:81], s[80:81], s[98:99]
    v_cmp_ne_u32 vcc, v81, v244
    v_cmp_ne_u32_e64 s[98:99], v83, v245
    s_nop 0
    s_or_b64 s[98:99], s[98:99], vcc
    s_and_b64 s[82:83], s[82:83], s[98:99]
    s_or_b64 s[98:99], s[76:77], s[78:79]
    s_or_b64 s[98:99], s[98:99], s[80:81]
    s_or_b64 s[98:99], s[98:99], s[82:83]
    s_cbranch_scc0 L_mdone_49
    s_sub_u32 s66, s66, 1
    s_cbranch_scc0 L_mtop_48
L_mdone_49:
    v_add_f32 v212, v68, v72
    v_add_f32 v213, v70, v74
    v_add_f32 v214, v76, v80
    v_add_f32 v215, v78, v82
    s_nop 0
    v_add_f32_dpp v212, v212, v212 row_ror:4 row_mask:0xf bank_mask:0xf
    v_add_f32_dpp v213, v213, v213 row_ror:4 row_mask:0xf bank_mask:0xf
    v_add_f32_dpp v214, v214, v214 row_ror:4 row_mask:0xf bank_mask:0xf
    v_add_f32_dpp v215, v215, v215 row_ror:4 row_mask:0xf bank_mask:0xf
    v_add_f32_dpp v212, v212, v212 row_ror:8 row_mask:0xf bank_mask:0xf
    v_add_f32_dpp v213, v213, v213 row_ror:8 row_mask:0xf bank_mask:0xf
    v_add_f32_dpp v214, v214, v214 row_ror:8 row_mask:0xf bank_mask:0xf
    v_add_f32_dpp v215, v215, v215 row_ror:8 row_mask:0xf bank_mask:0xf
    v_mov_b32 v18, v212
    v_mov_b32 v19, v213
    v_mov_b32 v20, v214
    v_mov_b32 v21, v215
    v_permlane16_swap_b32 v212, v18
    v_permlane16_swap_b32 v213, v19
    v_permlane16_swap_b32 v214, v20
    v_permlane16_swap_b32 v215, v21
    s_nop 0
    v_add_f32 v212, v212, v18
    v_add_f32 v213, v213, v19
    v_add_f32 v214, v214, v20
    v_add_f32 v215, v215, v21
    v_mov_b32 v18, v212
    v_mov_b32 v19, v213
    v_mov_b32 v20, v214
    v_mov_b32 v21, v215
    v_permlane32_swap_b32 v212, v18
    v_permlane32_swap_b32 v213, v19
    v_permlane32_swap_b32 v214, v20
    v_permlane32_swap_b32 v215, v21
    s_nop 0
    v_add_f32 v212, v212, v18
    v_add_f32 v213, v213, v19
    v_add_f32 v214, v214, v20
    v_add_f32 v215, v215, v21
    s_mov_b32 s74, 0xf0f0f0f0
    s_mov_b32 s75, 0xf0f0f0f0
    v_cndmask_b32_e64 v220, v212, v213, s[74:75]
    v_cndmask_b32_e64 v221, v214, v215, s[74:75]
    v_lshlrev_b32 v222, 16, v10
    v_and_b32 v223, 0xffff0000, v10
    v_cndmask_b32_e64 v222, v222, v223, s[74:75]
    v_cvt_pk_bf16_f32 v221, v221, v221
    v_and_b32 v221, 0xffff0000, v221
    v_cvt_pk_bf16_f32 v220, v220, v220
    v_and_b32 v220, 0xffff0000, v220
    v_mul_f32 v226, 0xbfb8aa3b, v221
    v_exp_f32 v226, v226
    s_nop 0
    v_add_f32 v226, 1.0, v226
    v_rcp_f32 v226, v226
    s_nop 0
    v_mul_f32 v221, v221, v226
    v_cvt_pk_bf16_f32 v221, v221, v221
    v_and_b32 v221, 0xffff0000, v221
    v_mul_f32 v220, v220, v221
    v_cvt_pk_bf16_f32 v220, v220, v220
    v_and_b32 v220, 0xffff0000, v220
    v_add_f32 v220, v220, v222
    s_nop 1
    v_mov_b32_dpp v221, v220 row_ror:12 row_mask:0xf bank_mask:0xf
    v_lshlrev_b32 v18, 2, v1
    v_cvt_pk_bf16_f32 v220, v220, v221
    s_lshl_b32 s57, s2, 4
    s_mov_b64 exec, 0xf
    buffer_store_dword v220, v18, s[40:43], s57 offen sc0 sc1
    s_cmp_lg_u32 s2, 0
    s_cbranch_scc1 L_noep_54
    s_mov_b64 exec, 1
    buffer_store_dwordx2 v[244:245], off, s[44:47], 0 sc0 sc1
L_noep_54:
L_EXIT:
L_END:
    s_endpgm
L_CODE_END:
.section .rodata,"a"
.p2align 6
.amdhsa_kernel recurrent_scan__mha_block_cached__swiglu_ffn__decode_kernel
  .amdhsa_next_free_vgpr 256
  .amdhsa_next_free_sgpr 102
  .amdhsa_accum_offset 256
  .amdhsa_group_segment_fixed_size 0
  .amdhsa_kernarg_size 96
  .amdhsa_user_sgpr_count 2
  .amdhsa_user_sgpr_kernarg_segment_ptr 1
  .amdhsa_system_sgpr_workgroup_id_x 1
  .amdhsa_float_denorm_mode_32 3
.end_amdhsa_kernel
```
